```python
import torch

def _softmax(x, axis=-1):
    return torch.softmax(x, dim=axis)

def _gelu(x):
    return torch.nn.functional.gelu(x, approximate='tanh')

def _silu(x):
    return torch.nn.functional.silu(x)

def _sigmoid(x):
    return torch.sigmoid(x)

def _layernorm(x, axis=-1, eps=1e-05):
    m = x.mean(dim=axis, keepdim=True)
    v = x.var(dim=axis, keepdim=True, unbiased=False)
    return (x - m) / torch.sqrt(v + eps)

def _scatter_add(tgt, idx, src, axis=0):
    return tgt.clone().index_add_(axis, idx, src)

def _segment_sum(src, seg, n):
    out = torch.zeros((n,) + src.shape[1:], dtype=src.dtype)
    return out.index_add_(0, seg, src)

def _pad(x, pw):
    flat = tuple((v for pair in reversed(pw) for v in pair))
    return torch.nn.functional.pad(x, flat)
kernel_name = 'adaLN_cond__spectral_fnet__moe_arch_mod__prompt'

def setup_inputs():

    _w = lambda a: (lambda t: t.to(torch.bfloat16) if t.is_floating_point() else t)(torch.as_tensor(a))

    def _A_setup():
        B, S, D = (1, 2048, 448)
        ns = torch.arange(S)[:, None] * torch.arange(S)[None, :]
        nd = torch.arange(D)[:, None] * torch.arange(D)[None, :]
        Ws_re = torch.cos(-2.0 * torch.pi * ns / S).to(float)
        Ws_im = torch.sin(-2.0 * torch.pi * ns / S).to(float)
        Wd_re = torch.cos(-2.0 * torch.pi * nd / D).to(float)
        Wd_im = torch.sin(-2.0 * torch.pi * nd / D).to(float)
        return {'x': _w((lambda *s: torch.randn(*s, dtype=torch.bfloat16) * 0.05)(B, S, D)), 'dft_seq_re': _w(Ws_re), 'dft_seq_im': _w(Ws_im), 'dft_hid_re': _w(Wd_re), 'dft_hid_im': _w(Wd_im)}
    _A_in = _A_setup()

    def _B_setup():
        B, S, D, F, C = (1, 2048, 448, 1792, 1)
        return {'x': _w((lambda *s: torch.randn(*s, dtype=torch.bfloat16) * 0.05)(B, S, D)), 'w_r': _w((lambda *s: torch.randn(*s, dtype=torch.bfloat16) * 3.2)(D)), 'w_gate': _w((lambda *s: torch.randn(*s, dtype=torch.bfloat16) * 0.8)(D, F)), 'w_up': _w((lambda *s: torch.randn(*s, dtype=torch.bfloat16) * 0.8)(D, F)), 'w_down': _w((lambda *s: torch.randn(*s, dtype=torch.bfloat16) * 0.8)(F, D))}
    _B_in = _B_setup()
    return {'A_x': _A_in['x'], 'A_dft_seq_re': _A_in['dft_seq_re'], 'A_dft_seq_im': _A_in['dft_seq_im'], 'A_dft_hid_re': _A_in['dft_hid_re'], 'A_dft_hid_im': _A_in['dft_hid_im'], 'B_x': _B_in['x'], 'B_w_r': _B_in['w_r'], 'B_w_gate': _B_in['w_gate'], 'B_w_up': _B_in['w_up'], 'B_w_down': _B_in['w_down'], 'c': _w((lambda *s: torch.randn(*s, dtype=torch.bfloat16) * 0.1)(1, 448) * 8.0), 'w_mod': _w((lambda *s: torch.randn(*s, dtype=torch.bfloat16) * 0.1)(448, 6 * 448) * 448 ** (-0.5) * 8.0)}

def reference(A_x, A_dft_seq_re, A_dft_seq_im, A_dft_hid_re, A_dft_hid_im, B_x, B_w_r, B_w_gate, B_w_up, B_w_down, c, w_mod):

    def _A_ref(x, dft_seq_re, dft_seq_im, dft_hid_re, dft_hid_im):
        a = torch.einsum('bsd,ed->bse', x, dft_hid_re)
        b = torch.einsum('bsd,ed->bse', x, dft_hid_im)
        y = torch.einsum('ts,bse->bte', dft_seq_re, a) - torch.einsum('ts,bse->bte', dft_seq_im, b)
        return y

    def _B_ref(x, w_r, w_gate, w_up, w_down):
        B, S, D = x.shape
        C = 1
        r = x @ w_r
        idx = torch.argsort(-r, axis=-1)[:, :C]
        idx_e = (lambda x, n, axis: torch.repeat_interleave(x, n, dim=axis))(idx.reshape(B, C, 1), D, axis=2)
        x_sel = (lambda x, i, axis: torch.take_along_dim(x, i, dim=axis))(x, idx_e, axis=1)
        g = _silu(x_sel @ w_gate)
        u = x_sel @ w_up
        y = g * u @ w_down
        r_sel = _sigmoid((lambda x, i, axis: torch.take_along_dim(x, i, dim=axis))(r, idx, axis=1))
        y = y * r_sel.reshape(B, C, 1)
        b_off = (torch.arange(B) * S).reshape(B, 1)
        flat_idx = (idx + b_off).reshape(B * C)
        zero = (x * 0.0).reshape(B * S, D)
        upd = _scatter_add(zero, flat_idx, y.reshape(B * C, D), axis=0)
        return x + upd.reshape(B, S, D)
    x = A_x
    mod = (_silu(c) @ w_mod).reshape(c.shape[0], 6, 1, -1)
    sa, ca, ga, sb, cb, gb = (mod[:, 0].clone(), mod[:, 1].clone(), mod[:, 2].clone(), mod[:, 3].clone(), mod[:, 4].clone(), mod[:, 5].clone())
    h = _layernorm(x, axis=-1) * (1 + ca) + sa
    x = x + ga * _A_ref(h, A_dft_seq_re, A_dft_seq_im, A_dft_hid_re, A_dft_hid_im)
    h = _layernorm(x, axis=-1) * (1 + cb) + sb
    x = x + gb * _B_ref(h, B_w_r, B_w_gate, B_w_up, B_w_down)
    return x
```

```asm
; @launch grid=(256,1,1) block=(512,1,1) lds=110016
.amdgcn_target "amdgcn-amd-amdhsa--gfx950"
.text
.globl adaLN_cond__spectral_fnet__moe_arch_mod__prompt_kernel
.p2align 12
.fill 832, 4, 0xbf810000
.p2align 8
.type adaLN_cond__spectral_fnet__moe_arch_mod__prompt_kernel,@function
adaLN_cond__spectral_fnet__moe_arch_mod__prompt_kernel:
    s_load_dwordx2 s[8:9], s[0:1], 0
    s_load_dwordx16 s[48:63], s[0:1], 56
    s_bitcmp1_b32 s2, 0
    s_cbranch_scc0 L_mod
    s_bfe_u32 s20, s2, 131073
    s_bfe_u32 s21, s2, 0x30003
    s_lshl2_add_u32 s23, s21, s20
    s_bfe_u32 s44, s2, 0x20006
    s_mulk_i32 s23, 896
    s_lshl_b32 s44, s44, 8
    s_min_u32 s21, s44, 640
    s_add_u32 s44, s21, s23
    v_lshrrev_b32 v1, 3, v0
    v_lshlrev_b32 v2, 4, v0
    s_movk_i32 s22, 28544
    v_mad_u32_u24 v3, v1, s22, v2
    s_mov_b32 s10, -1
    s_mov_b32 s11, 0x00020000
    s_waitcnt lgkmcnt(0)
    buffer_load_dwordx4 v[8:11], v3, s[8:11], s44 offen
    buffer_load_dwordx4 v[12:15], v3, s[8:11], s44 offen offset:128
    s_add_u32 s31, s23, 256
    s_cmp_gt_u32 s21, 64
    s_cselect_b32 s45, s23, s31
    s_bitcmp1_b32 s21, 9
    s_cselect_b32 s46, s23, s31
    s_bitcmp1_b32 s21, 7
    s_cselect_b32 s47, s23, s31
    s_cmp_ge_u32 s2, 256
    s_cbranch_scc1 L_end
    s_mov_b32 s10, 1835008
    s_mov_b64 s[6:7], s[62:63]
    s_mov_b64 s[16:17], s[58:59]
    s_mov_b32 s62, 2109440
    s_load_dword s63, s[6:7], s62
    v_readfirstlane_b32 s28, v0
    s_lshr_b32 s2, s2, 3
    s_lshl2_add_u32 s2, s2, s20
    s_bfe_u32 s20, s2, 0x20005
    s_and_b32 s21, s2, 31
    v_and_b32 v2, 7, v0
    s_lshr_b32 s28, s28, 6
    s_mov_b32 s12, s6
    s_and_b32 s13, s7, 0xffff
    s_mov_b32 s14, 4194304
    s_mov_b32 s15, 0x00020000
    v_mov_b32 v72, -1
    v_mov_b32 v73, -1
    v_mov_b32 v74, -1
    v_mov_b32 v75, -1
    v_and_b32 v76, 63, v0
    v_lshlrev_b32 v76, 4, v76
    s_mul_i32 s32, s2, 3712
    s_mul_i32 s33, s28, 464
    s_add_u32 s32, s32, s33
    s_add_u32 s32, s32, 2162688
    s_mov_b32 s53, s32
    s_barrier
    s_cmp_ge_u32 s28, 4
    s_cbranch_scc1 L_late
    buffer_load_dwordx4 v[16:19], v3, s[8:11], s45 offen offset:0
    buffer_load_dwordx4 v[20:23], v3, s[8:11], s45 offen offset:128
    buffer_load_dwordx4 v[24:27], v3, s[8:11], s46 offen offset:256
    buffer_load_dwordx4 v[28:31], v3, s[8:11], s46 offen offset:384
    buffer_load_dwordx4 v[32:35], v3, s[8:11], s47 offen offset:512
L_late:
    v_and_b32 v4, 15, v0
    v_bfe_u32 v5, v0, 4, 2
    v_bfe_u32 v6, v0, 6, 2
    v_lshrrev_b32 v7, 8, v0
    v_lshl_add_u32 v45, v6, 4, v4
    v_lshrrev_b32 v46, 1, v45
    v_and_b32 v47, 1, v45
    v_cvt_f32_u32 v48, v46
    v_cvt_f32_u32 v49, v47
    v_cmp_eq_u32 vcc, 1, v45
    v_mul_f32 v48, 0x3c800000, v48
    v_mul_f32 v49, 0x3e800000, v49
    v_cndmask_b32 v48, v48, 0.5, vcc
    v_cndmask_b32 v49, v49, 0, vcc
    v_lshlrev_b32 v50, 2, v5
    v_cvt_f32_u32 v50, v50
    v_fma_f32 v49, v48, v50, v49
    v_fmamk_f32 v60, v48, 0x00000000, v49
    v_fmamk_f32 v61, v48, 0x3f800000, v49
    v_fmamk_f32 v62, v48, 0x40000000, v49
    v_fmamk_f32 v63, v48, 0x40400000, v49
    v_cos_f32 v60, v60
    v_cos_f32 v61, v61
    v_cos_f32 v62, v62
    v_cos_f32 v63, v63
    v_cvt_pk_bf16_f32 v52, v60, v61
    v_cvt_pk_bf16_f32 v53, v62, v63
    v_fmamk_f32 v60, v48, 0x41800000, v49
    v_fmamk_f32 v61, v48, 0x41880000, v49
    v_fmamk_f32 v62, v48, 0x41900000, v49
    v_fmamk_f32 v63, v48, 0x41980000, v49
    v_cos_f32 v60, v60
    v_cos_f32 v61, v61
    v_cos_f32 v62, v62
    v_cos_f32 v63, v63
    v_cvt_pk_bf16_f32 v54, v60, v61
    v_cvt_pk_bf16_f32 v55, v62, v63
    v_fmamk_f32 v60, v48, 0x42000000, v49
    v_fmamk_f32 v61, v48, 0x42040000, v49
    v_fmamk_f32 v62, v48, 0x42080000, v49
    v_fmamk_f32 v63, v48, 0x420c0000, v49
    v_cos_f32 v60, v60
    v_cos_f32 v61, v61
    v_cos_f32 v62, v62
    v_cos_f32 v63, v63
    v_cvt_pk_bf16_f32 v56, v60, v61
    v_cvt_pk_bf16_f32 v57, v62, v63
    v_fmamk_f32 v60, v48, 0x42400000, v49
    v_fmamk_f32 v61, v48, 0x42440000, v49
    v_fmamk_f32 v62, v48, 0x42480000, v49
    v_fmamk_f32 v63, v48, 0x424c0000, v49
    v_cos_f32 v60, v60
    v_cos_f32 v61, v61
    v_cos_f32 v62, v62
    v_cos_f32 v63, v63
    v_cvt_pk_bf16_f32 v58, v60, v61
    v_cvt_pk_bf16_f32 v59, v62, v63
    v_mul_u32_u24 v62, 288, v1
    v_lshrrev_b32 v63, 2, v2
    v_lshl_add_u32 v62, v63, 6, v62
    v_and_b32 v63, 3, v2
    v_lshl_add_u32 v62, v63, 3, v62
    v_add_u32 v62, 88128, v62
    v_bfe_u32 v63, v0, 2, 2
    v_lshl_add_u32 v63, v5, 2, v63
    v_mul_u32_u24 v63, 288, v63
    v_and_b32 v64, 3, v0
    v_lshl_add_u32 v63, v64, 3, v63
    v_lshl_add_u32 v63, v7, 7, v63
    v_add_u32 v63, 88128, v63
    v_and_b32 v64, 0x37, v45
    v_lshrrev_b32 v64, 1, v64
    v_lshl_add_u32 v64, v64, 6, v47
    v_mul_u32_u24 v64, 896, v64
    v_lshrrev_b32 v69, 3, v4
    v_lshl_add_u32 v64, v69, 6, v64
    v_lshl_add_u32 v64, v7, 7, v64
    v_lshl_add_u32 v64, v5, 4, v64
    s_add_u32 s33, s23, s44
    s_lshr_b32 s51, s28, 2
    s_lshl_b32 s51, s51, 2
    s_or_b32 s51, s51, s20
    s_cmp_eq_u32 s51, 3
    s_cselect_b32 s33, 0x40000000, s33
    s_mov_b32 s37, 0x3f803f80
    v_mov_b32 v65, 0
    v_mov_b32 v66, 0
    v_mov_b32 v67, 0
    v_mov_b32 v68, 0
    s_load_dwordx2 s[18:19], s[0:1], 48
    v_and_b32 v242, 63, v0
    v_lshlrev_b32 v242, 4, v242
    s_and_b32 s29, s2, 3
    s_bfe_u32 s35, s2, 196612
    s_lshl_b32 s35, s35, 2
    s_add_u32 s29, s29, s35
    s_bfe_u32 s35, s2, 131074
    s_lshl_b32 s30, s35, 9
    s_add_u32 s30, s30, s29
    s_mov_b32 s55, 64
    s_mov_b32 s32, 1.0
    s_mov_b32 s56, 1.0
    s_mov_b32 s54, 0
    s_cmp_lg_u32 s29, 0
    s_cbranch_scc1 L_ids_done
    s_mov_b32 s56, 0
    s_cmp_lt_u32 s35, 2
    s_cbranch_scc1 L_mode1
    s_sub_u32 s30, s30, 992
    s_mov_b32 s32, 0
    s_mov_b32 s54, 1.0
L_mode1:
    s_cmp_lg_u32 s2, 128
    s_cbranch_scc1 L_ids_done
    s_movk_i32 s30, 1024
    s_mov_b32 s55, 0
L_ids_done:
    s_mul_i32 s36, s55, s28
    s_add_u32 s36, s36, s30
    s_sub_u32 s57, 2048, s36
    s_and_b32 s57, s57, 2047
    s_mul_i32 s41, s36, 896
    s_mul_i32 s42, s57, 896
    v_lshlrev_b32 v240, 5, v4
    v_lshl_add_u32 v240, v5, 3, v240
    v_add_u32 v241, 512, v240
    v_cmp_gt_u32 vcc, 12, v4
    v_mov_b32 v243, 0x20000000
    s_nop 0
    v_cndmask_b32 v241, v243, v241, vcc
    s_cmp_lt_u32 s28, 4
    s_cbranch_scc1 L_early
    buffer_load_dwordx4 v[16:19], v3, s[8:11], s45 offen offset:0
    buffer_load_dwordx4 v[20:23], v3, s[8:11], s45 offen offset:128
    buffer_load_dwordx4 v[24:27], v3, s[8:11], s46 offen offset:256
    buffer_load_dwordx4 v[28:31], v3, s[8:11], s46 offen offset:384
    buffer_load_dwordx4 v[32:35], v3, s[8:11], s47 offen offset:512
L_early:
    s_mov_b32 s66, s2
    s_mov_b32 s67, s28
    s_lshl_b32 s2, s2, 1
    s_getpc_b64 s[24:25]
    s_lshr_b32 s26, s2, 3
    s_min_u32 s26, s26, ((L_skipA-L_bmain+1023)>>10)-1
    v_readfirstlane_b32 s28, v0
    s_lshl_b32 s26, s26, 10
    s_lshl1_add_u32 s26, s28, s26
    s_add_u32 s26, s26, L_bmain-L_early-16
    s_add_u32 s24, s24, s26
    s_addc_u32 s25, s25, 0
    v_mov_b32 v250, s24
    v_mov_b32 v251, s25
    s_mov_b64 exec, 1
    global_load_dword v223, v[250:251], off offset:0
    s_mov_b64 exec, -1
    s_mov_b32 s2, s66
    s_mov_b32 s28, s67
    s_waitcnt vmcnt(7)
    v_dot2c_f32_bf16 v65, s37, v8
    v_dot2c_f32_bf16 v67, v8, v8
    v_dot2c_f32_bf16 v66, s37, v9
    v_dot2c_f32_bf16 v68, v9, v9
    v_dot2c_f32_bf16 v65, s37, v10
    v_dot2c_f32_bf16 v67, v10, v10
    v_dot2c_f32_bf16 v66, s37, v11
    v_dot2c_f32_bf16 v68, v11, v11
    s_waitcnt vmcnt(6)
    v_dot2c_f32_bf16 v65, s37, v12
    v_dot2c_f32_bf16 v67, v12, v12
    v_dot2c_f32_bf16 v66, s37, v13
    v_dot2c_f32_bf16 v68, v13, v13
    v_dot2c_f32_bf16 v65, s37, v14
    v_dot2c_f32_bf16 v67, v14, v14
    v_dot2c_f32_bf16 v66, s37, v15
    v_dot2c_f32_bf16 v68, v15, v15
    v_lshlrev_b32 v80, 16, v8
    v_and_b32 v81, 0xffff0000, v8
    v_lshlrev_b32 v82, 16, v9
    v_and_b32 v83, 0xffff0000, v9
    v_lshlrev_b32 v84, 16, v10
    v_and_b32 v85, 0xffff0000, v10
    v_lshlrev_b32 v86, 16, v11
    v_and_b32 v87, 0xffff0000, v11
    v_lshlrev_b32 v88, 16, v12
    v_and_b32 v89, 0xffff0000, v12
    v_lshlrev_b32 v90, 16, v13
    v_and_b32 v91, 0xffff0000, v13
    v_lshlrev_b32 v92, 16, v14
    v_and_b32 v93, 0xffff0000, v14
    v_lshlrev_b32 v94, 16, v15
    v_and_b32 v95, 0xffff0000, v15
    s_waitcnt vmcnt(5)
    v_dot2c_f32_bf16 v65, s37, v16
    v_dot2c_f32_bf16 v67, v16, v16
    v_dot2c_f32_bf16 v66, s37, v17
    v_dot2c_f32_bf16 v68, v17, v17
    v_dot2c_f32_bf16 v65, s37, v18
    v_dot2c_f32_bf16 v67, v18, v18
    v_dot2c_f32_bf16 v66, s37, v19
    v_dot2c_f32_bf16 v68, v19, v19
    s_waitcnt vmcnt(4)
    v_dot2c_f32_bf16 v65, s37, v20
    v_dot2c_f32_bf16 v67, v20, v20
    v_dot2c_f32_bf16 v66, s37, v21
    v_dot2c_f32_bf16 v68, v21, v21
    v_dot2c_f32_bf16 v65, s37, v22
    v_dot2c_f32_bf16 v67, v22, v22
    v_dot2c_f32_bf16 v66, s37, v23
    v_dot2c_f32_bf16 v68, v23, v23
    s_waitcnt vmcnt(3)
    v_dot2c_f32_bf16 v65, s37, v24
    v_dot2c_f32_bf16 v67, v24, v24
    v_dot2c_f32_bf16 v66, s37, v25
    v_dot2c_f32_bf16 v68, v25, v25
    v_dot2c_f32_bf16 v65, s37, v26
    v_dot2c_f32_bf16 v67, v26, v26
    v_dot2c_f32_bf16 v66, s37, v27
    v_dot2c_f32_bf16 v68, v27, v27
    s_waitcnt vmcnt(2)
    v_dot2c_f32_bf16 v65, s37, v28
    v_dot2c_f32_bf16 v67, v28, v28
    v_dot2c_f32_bf16 v66, s37, v29
    v_dot2c_f32_bf16 v68, v29, v29
    v_dot2c_f32_bf16 v65, s37, v30
    v_dot2c_f32_bf16 v67, v30, v30
    v_dot2c_f32_bf16 v66, s37, v31
    v_dot2c_f32_bf16 v68, v31, v31
    s_waitcnt vmcnt(1)
    v_dot2c_f32_bf16 v65, s37, v32
    v_dot2c_f32_bf16 v67, v32, v32
    v_dot2c_f32_bf16 v66, s37, v33
    v_dot2c_f32_bf16 v68, v33, v33
    v_dot2c_f32_bf16 v65, s37, v34
    v_dot2c_f32_bf16 v67, v34, v34
    v_dot2c_f32_bf16 v66, s37, v35
    v_dot2c_f32_bf16 v68, v35, v35
    s_mov_b64 exec, 0x1fffffff
    buffer_store_dwordx4 v[72:75], v76, s[12:15], s53 offen sc1
    s_mov_b64 exec, -1
    buffer_load_dwordx2 v[104:105], v240, s[8:11], s41 offen
    buffer_load_dwordx2 v[106:107], v241, s[8:11], s41 offen
    buffer_load_dwordx2 v[232:233], v240, s[8:11], s42 offen
    buffer_load_dwordx2 v[234:235], v241, s[8:11], s42 offen
    v_add_f32 v65, v65, v66
    v_add_f32 v67, v67, v68
    s_nop 0
    v_add_f32_dpp v65, v65, v65 quad_perm:[1,0,3,2] row_mask:0xf bank_mask:0xf
    v_add_f32_dpp v67, v67, v67 quad_perm:[1,0,3,2] row_mask:0xf bank_mask:0xf
    s_nop 0
    v_add_f32_dpp v65, v65, v65 quad_perm:[2,3,0,1] row_mask:0xf bank_mask:0xf
    v_add_f32_dpp v67, v67, v67 quad_perm:[2,3,0,1] row_mask:0xf bank_mask:0xf
    s_nop 0
    v_add_f32_dpp v65, v65, v65 row_half_mirror row_mask:0xf bank_mask:0xf
    v_add_f32_dpp v67, v67, v67 row_half_mirror row_mask:0xf bank_mask:0xf
    v_mul_f32 v65, 0x3b124925, v65
    v_mul_f32 v67, 0x3b124925, v67
    v_fma_f32 v67, -v65, v65, v67
    v_max_f32 v67, 0, v67
    v_cvt_pk_bf16_f32 v66, v65, v67
    v_lshlrev_b32 v65, 16, v66
    v_and_b32 v67, 0xffff0000, v66
    v_add_f32 v67, 0x3727c5ac, v67
    v_cvt_pk_bf16_f32 v67, v67, v67
    v_lshlrev_b32 v67, 16, v67
    v_sqrt_f32 v67, v67
    s_nop 0
    v_cvt_pk_bf16_f32 v67, v67, v67
    v_lshlrev_b32 v67, 16, v67
    v_rcp_f32 v67, v67
    s_nop 0
    v_mul_f32 v65, v65, v67
    v_fma_f32 v80, v80, v67, -v65
    v_fma_f32 v81, v81, v67, -v65
    v_fma_f32 v82, v82, v67, -v65
    v_fma_f32 v83, v83, v67, -v65
    v_fma_f32 v84, v84, v67, -v65
    v_fma_f32 v85, v85, v67, -v65
    v_fma_f32 v86, v86, v67, -v65
    v_fma_f32 v87, v87, v67, -v65
    v_cvt_pk_bf16_f32 v96, v80, v81
    v_cvt_pk_bf16_f32 v97, v82, v83
    v_cvt_pk_bf16_f32 v98, v84, v85
    v_cvt_pk_bf16_f32 v99, v86, v87
    ds_write2_b64 v62, v[96:97], v[98:99] offset0:0 offset1:4
    v_fma_f32 v88, v88, v67, -v65
    v_fma_f32 v89, v89, v67, -v65
    v_fma_f32 v90, v90, v67, -v65
    v_fma_f32 v91, v91, v67, -v65
    v_fma_f32 v92, v92, v67, -v65
    v_fma_f32 v93, v93, v67, -v65
    v_fma_f32 v94, v94, v67, -v65
    v_fma_f32 v95, v95, v67, -v65
    v_cvt_pk_bf16_f32 v100, v88, v89
    v_cvt_pk_bf16_f32 v101, v90, v91
    v_cvt_pk_bf16_f32 v102, v92, v93
    v_cvt_pk_bf16_f32 v103, v94, v95
    ds_write2_b64 v62, v[100:101], v[102:103] offset0:16 offset1:20
    s_waitcnt lgkmcnt(0)
    s_barrier
    ds_read_b64_tr_b16 v[8:9], v63 offset:0
    ds_read_b64_tr_b16 v[10:11], v63 offset:4608
    ds_read_b64_tr_b16 v[12:13], v63 offset:9216
    ds_read_b64_tr_b16 v[14:15], v63 offset:13824
    ds_read_b64_tr_b16 v[16:17], v63 offset:32
    ds_read_b64_tr_b16 v[18:19], v63 offset:4640
    ds_read_b64_tr_b16 v[20:21], v63 offset:9248
    ds_read_b64_tr_b16 v[22:23], v63 offset:13856
    ds_read_b64_tr_b16 v[24:25], v63 offset:64
    ds_read_b64_tr_b16 v[26:27], v63 offset:4672
    ds_read_b64_tr_b16 v[28:29], v63 offset:9280
    ds_read_b64_tr_b16 v[30:31], v63 offset:13888
    s_mul_i32 s63, s63, 1664525
    s_add_u32 s63, s63, 1013904223
    s_lshl_b32 s34, s21, 2
    s_add_u32 s34, s34, s20
    s_mul_i32 s34, s34, 128
    s_add_u32 s34, s34, 2818048
    s_waitcnt lgkmcnt(8)
    v_mfma_f32_16x16x32_bf16 v[80:83], v[8:11], v[52:55], 0
    v_mfma_f32_16x16x32_bf16 v[80:83], v[12:15], v[56:59], v[80:83]
    ds_read_b64_tr_b16 v[32:33], v63 offset:96
    ds_read_b64_tr_b16 v[34:35], v63 offset:4704
    ds_read_b64_tr_b16 v[36:37], v63 offset:9312
    ds_read_b64_tr_b16 v[38:39], v63 offset:13920
    s_waitcnt lgkmcnt(8)
    v_mfma_f32_16x16x32_bf16 v[84:87], v[16:19], v[52:55], 0
    v_mfma_f32_16x16x32_bf16 v[84:87], v[20:23], v[56:59], v[84:87]
    s_waitcnt lgkmcnt(4)
    v_mfma_f32_16x16x32_bf16 v[88:91], v[24:27], v[52:55], 0
    v_mfma_f32_16x16x32_bf16 v[88:91], v[28:31], v[56:59], v[88:91]
    s_waitcnt lgkmcnt(0)
    v_mfma_f32_16x16x32_bf16 v[92:95], v[32:35], v[52:55], 0
    v_mfma_f32_16x16x32_bf16 v[92:95], v[36:39], v[56:59], v[92:95]
    v_mov_b32 v40, s63
    v_lshlrev_b32 v41, 15, v0
    v_cvt_pk_bf16_f32 v96, v80, v81
    v_cvt_pk_bf16_f32 v44, v80, v81
    v_cvt_pk_bf16_f32 v97, v82, v83
    v_cvt_pk_bf16_f32 v45, v82, v83
    v_cvt_pk_bf16_f32 v98, v84, v85
    v_cvt_pk_bf16_f32 v46, v84, v85
    v_cvt_pk_bf16_f32 v99, v86, v87
    v_cvt_pk_bf16_f32 v47, v86, v87
    s_add_u32 s45, s33, 229376
    v_cvt_pk_bf16_f32 v100, v88, v89
    v_cvt_pk_bf16_f32 v101, v90, v91
    v_cvt_pk_bf16_f32 v102, v92, v93
    v_cvt_pk_bf16_f32 v103, v94, v95
    v_mov_b32_dpp v96, v100 row_ror:8 row_mask:0xf bank_mask:0xc
    v_mov_b32_dpp v97, v101 row_ror:8 row_mask:0xf bank_mask:0xc
    v_mov_b32_dpp v98, v102 row_ror:8 row_mask:0xf bank_mask:0xc
    v_mov_b32_dpp v99, v103 row_ror:8 row_mask:0xf bank_mask:0xc
    buffer_store_dwordx4 v[96:99], v64, s[12:15], s33 offen sc1
    v_mov_b32_dpp v100, v44 row_ror:8 row_mask:0xf bank_mask:0x3
    v_mov_b32_dpp v101, v45 row_ror:8 row_mask:0xf bank_mask:0x3
    v_mov_b32_dpp v102, v46 row_ror:8 row_mask:0xf bank_mask:0x3
    v_mov_b32_dpp v103, v47 row_ror:8 row_mask:0xf bank_mask:0x3
    buffer_store_dwordx4 v[100:103], v64, s[12:15], s45 offen sc1
L_joinA:
    s_bfe_u32 s58, s28, 0x10001
    s_lshl_b32 s58, s58, 4
    v_add_u32 v244, s58, v4
    v_sub_u32 v245, 27, v244
    s_cmp_ge_u32 s28, 4
    s_cselect_b64 s[60:61], -1, 0
    v_cndmask_b32 v245, v244, v245, s[60:61]
    v_cvt_f32_i32 v245, v245
    v_mul_f32 v245, 0x3d124925, v245
    s_and_b32 s59, s28, 1
    s_lshl_b32 s59, s59, 4
    v_lshl_add_u32 v246, v5, 2, s59
    v_cmp_gt_u32 s[64:65], 28, v246
    v_cmp_gt_u32 vcc, 28, v244
    s_nop 0
    s_and_b64 s[64:65], s[64:65], vcc
    v_cvt_f32_u32 v246, v246
    v_mul_f32 v176, v246, v245
    v_add_f32 v177, v176, v245
    v_add_f32 v178, v177, v245
    v_add_f32 v179, v178, v245
    v_cos_f32 v180, v176
    v_cos_f32 v181, v177
    v_cos_f32 v182, v178
    v_cos_f32 v183, v179
    v_sin_f32 v176, v176
    v_sin_f32 v177, v177
    v_sin_f32 v178, v178
    v_sin_f32 v179, v179
    v_cvt_pk_bf16_f32 v250, v180, v176
    v_cvt_pk_bf16_f32 v251, v181, v177
    v_cvt_pk_bf16_f32 v252, v182, v178
    v_cvt_pk_bf16_f32 v253, v183, v179
    v_cndmask_b32 v250, 0, v250, s[64:65]
    v_cndmask_b32 v251, 0, v251, s[64:65]
    v_cndmask_b32 v252, 0, v252, s[64:65]
    v_cndmask_b32 v253, 0, v253, s[64:65]
    v_mov_b32 v246, 0
    v_mov_b32 v247, 0
    ds_write_b64 v246, v[246:247] offset:28672
    s_lshl_b32 s59, s28, 10
    v_add_u32 v249, s59, v242
    ds_write_b128 v249, v[250:253] offset:0
    s_cmp_ge_u32 s28, 4
    s_cbranch_scc1 L_noextra
    s_cmp_lt_u32 s28, 2
    s_cbranch_scc0 L_h1quad
    v_and_b32 v244, 7, v4
    v_mul_u32_u24 v244, s55, v244
    v_add_u32 v244, s30, v244
    v_cvt_f32_u32 v244, v244
    v_mul_f32 v244, 0x3a000000, v244
    v_lshrrev_b32 v245, 3, v4
    v_cvt_f32_u32 v245, v245
    v_mul_f32 v245, 0x3e800000, v245
    s_and_b32 s59, s28, 1
    s_lshl_b32 s59, s59, 4
    v_lshl_add_u32 v246, v5, 1, s59
    v_cvt_f32_u32 v246, v246
    v_fma_f32 v176, v246, v244, v245
    v_add_f32 v177, v176, v244
    v_fmamk_f32 v178, v244, 0x41000000, v176
    v_add_f32 v179, v178, v244
    v_cos_f32 v180, v176
    v_cos_f32 v181, v177
    v_cos_f32 v182, v178
    v_cos_f32 v183, v179
    v_sin_f32 v176, v176
    v_sin_f32 v177, v177
    v_sin_f32 v178, v178
    v_sin_f32 v179, v179
    v_mul_f32 v176, s56, v176
    v_fmac_f32 v176, s54, v180
    v_mul_f32 v180, s32, v180
    v_mul_f32 v177, s56, v177
    v_fmac_f32 v177, s54, v181
    v_mul_f32 v181, s32, v181
    v_mul_f32 v178, s56, v178
    v_fmac_f32 v178, s54, v182
    v_mul_f32 v182, s32, v182
    v_mul_f32 v179, s56, v179
    v_fmac_f32 v179, s54, v183
    v_mul_f32 v183, s32, v183
    v_cvt_pk_bf16_f32 v250, v180, v176
    v_cvt_pk_bf16_f32 v251, v181, v177
    v_cvt_pk_bf16_f32 v252, v182, v178
    v_cvt_pk_bf16_f32 v253, v183, v179
    ds_write_b128 v249, v[250:253] offset:8192
    s_branch L_noextra
L_h1quad:
    v_and_b32 v245, 1, v4
    v_cvt_f32_u32 v245, v245
    v_mul_f32 v245, 0x3e800000, v245
    v_cvt_f32_u32 v246, v5
    s_and_b32 s59, s28, 1
    s_lshl_b32 s59, s59, 3
    v_lshrrev_b32 v244, 1, v4
    v_add_u32 v244, s59, v244
    v_cvt_f32_u32 v244, v244
    v_mul_f32 v244, 0x3d800000, v244
    v_fma_f32 v176, v246, v244, v245
    v_fmamk_f32 v177, v244, 0x40800000, v176
    v_fmamk_f32 v178, v244, 0x41000000, v176
    v_fmamk_f32 v179, v244, 0x41400000, v176
    v_cos_f32 v180, v176
    v_cos_f32 v181, v177
    v_cos_f32 v182, v178
    v_cos_f32 v183, v179
    v_sin_f32 v176, v176
    v_sin_f32 v177, v177
    v_sin_f32 v178, v178
    v_sin_f32 v179, v179
    v_cvt_pk_bf16_f32 v250, v180, v181
    v_cvt_pk_bf16_f32 v251, v182, v183
    v_cvt_pk_bf16_f32 v252, v176, v177
    v_cvt_pk_bf16_f32 v253, v178, v179
    ds_write_b128 v249, v[250:253] offset:8192
L_noextra:
    s_waitcnt vmcnt(0) lgkmcnt(0)
    s_barrier
    s_and_b32 s45, s2, 128
    s_or_b32 s45, s45, s28
    s_cbranch_scc1 L_bmain
    s_mov_b64 exec, 1
    buffer_store_dword v40, v41, s[12:15], s34 offen sc1
    s_mov_b64 exec, -1
    s_branch L_bmain
L_mod:
    s_getpc_b64 s[24:25]
    s_lshr_b32 s26, s2, 3
    s_min_u32 s26, s26, ((L_end-L_skipA)>>10)-1
    v_readfirstlane_b32 s28, v0
    s_lshl_b32 s26, s26, 10
    s_lshl1_add_u32 s26, s28, s26
    s_add_u32 s26, s26, L_skipA-L_mod-4
    s_add_u32 s24, s24, s26
    s_addc_u32 s25, s25, 0
    v_mov_b32 v250, s24
    v_mov_b32 v251, s25
    s_mov_b64 exec, 1
    global_load_dword v223, v[250:251], off offset:0
    s_mov_b64 exec, -1
    v_readfirstlane_b32 s28, v0
    s_bfe_u32 s3, s2, 131073
    s_lshr_b32 s21, s2, 3
    s_xor_b32 s20, s3, 0
    s_cmp_eq_u32 s2, 224
    s_cbranch_scc1 L_skipA
    s_cmp_ge_u32 s21, 28
    s_cbranch_scc1 L_end
    s_mul_i32 s29, s20, 28
    s_add_u32 s29, s29, s21
    s_add_u32 s2, s29, 129
    s_lshr_b32 s35, s29, 2
    s_mul_i32 s35, s35, 3
    s_and_b32 s39, s29, 3
    s_sub_u32 s39, s39, 1
    s_add_u32 s35, s35, s39
    s_lshl_b32 s38, s35, 8
    s_and_b32 s38, s38, 0x100
    v_xor_b32 v0, s38, v0
    v_lshrrev_b32 v1, 2, v0
    v_and_b32 v2, 3, v0
    v_mul_u32_u24 v3, 5376, v1
    v_lshl_add_u32 v3, v2, 4, v3
    v_lshlrev_b32 v4, 1, v1
    v_xor_b32 v0, s38, v0
    s_mul_i32 s36, s35, 64
    s_lshr_b32 s28, s28, 6
    s_waitcnt lgkmcnt(0)
    s_mov_b64 s[4:5], s[56:57]
    s_mov_b64 s[16:17], s[54:55]
    s_mov_b64 s[30:31], s[48:49]
    s_mov_b64 s[18:19], s[50:51]
    s_mov_b64 s[40:41], s[52:53]
    s_mov_b64 s[6:7], s[62:63]
    s_mov_b64 s[42:43], s[58:59]
    s_mov_b32 s57, s35
    s_mov_b32 s58, s36
    s_mov_b32 s8, s4
    s_and_b32 s9, s5, 0xffff
    s_mov_b32 s10, 2408448
    s_mov_b32 s11, 0x00020000
    s_mov_b32 s24, s16
    s_and_b32 s25, s17, 0xffff
    s_mov_b32 s26, 896
    s_mov_b32 s27, 0x00020000
    s_mov_b32 s12, s6
    s_and_b32 s13, s7, 0xffff
    s_mov_b32 s14, 4194304
    s_mov_b32 s15, 0x00020000
    s_mov_b32 s62, 2109440
    s_load_dword s63, s[6:7], s62
    s_cmp_ge_u32 s39, 3
    s_cbranch_scc1 L_nomod
    buffer_load_ushort v70, v4, s[24:27], 0 offen offset:0
    buffer_load_ushort v71, v4, s[24:27], 0 offen offset:256
    buffer_load_ushort v72, v4, s[24:27], 0 offen offset:512
    buffer_load_ushort v73, v4, s[24:27], 0 offen offset:768
    s_cmp_lt_u32 s57, 28
    s_cbranch_scc1 L_now
    s_waitcnt vmcnt(0)
L_now:
    buffer_load_dwordx4 v[8:11], v3, s[8:11], s58 offen
    s_add_u32 s58, s58, 688128
    buffer_load_dwordx4 v[12:15], v3, s[8:11], s58 offen
    s_add_u32 s58, s58, 688128
    buffer_load_dwordx4 v[16:19], v3, s[8:11], s58 offen
    s_add_u32 s58, s58, 688128
    buffer_load_dwordx4 v[20:23], v3, s[8:11], s58 offen
    s_add_u32 s58, s58, 688128
    s_branch L_nomod
.p2align 12
L_bmain:
    v_and_b32 v1, 63, v0
    v_and_b32 v2, 15, v0
    v_bfe_u32 v3, v0, 4, 2
    s_mov_b32 s37, s57
    s_mov_b32 s40, 0
    v_mul_u32_u24 v254, 128, v1
    v_add_u32 v254, s40, v254
    s_mul_i32 s40, s28, 2048
    s_add_u32 s40, s40, 2818048
    ds_read_b128 v[108:111], v242 offset:8192
    ds_read_b128 v[112:115], v242 offset:9216
    ds_read_b128 v[116:119], v242 offset:10240
    ds_read_b128 v[120:123], v242 offset:11264
    ds_read_b128 v[124:127], v242 offset:0
    ds_read_b128 v[128:131], v242 offset:1024
    ds_read_b128 v[132:135], v242 offset:2048
    ds_read_b128 v[136:139], v242 offset:3072
    ds_read_b128 v[140:143], v242 offset:4096
    ds_read_b128 v[144:147], v242 offset:5120
    ds_read_b128 v[148:151], v242 offset:6144
    ds_read_b128 v[152:155], v242 offset:7168
    s_lshl_b32 s38, s29, 6
    s_lshl_b32 s43, s28, 3
    s_add_u32 s38, s38, s43
    s_mul_i32 s38, s38, 896
    s_mul_i32 s43, s43, 928
    s_add_u32 s43, s43, 28736
    v_lshlrev_b32 v238, 1, v240
    v_lshlrev_b32 v239, 1, v241
    s_bfe_u32 s47, s2, 131074
    s_mul_i32 s46, s47, 1856
    s_mul_i32 s47, s47, 1792
    s_mov_b32 s64, 2834432
    s_mov_b32 s65, 0
    s_mov_b32 s68, -1
    s_mov_b32 s69, 0xffffff
    s_mov_b32 s66, 0xfffffff
    s_mov_b32 s67, 0
    s_mov_b32 s44, 2838016
    s_mov_b32 s20, s16
    s_and_b32 s21, s17, 0xffff
    s_mov_b32 s22, 1835008
    s_mov_b32 s23, 0x00020000
    s_mov_b32 s24, s18
    s_and_b32 s25, s19, 0xffff
    s_mov_b32 s26, 896
    s_mov_b32 s27, 0x00020000
    v_bfe_u32 v244, v0, 2, 2
    v_lshl_add_u32 v244, v3, 2, v244
    v_mul_u32_u24 v4, 928, v244
    v_and_b32 v244, 3, v0
    v_mul_u32_u24 v244, 56, v244
    s_lshl_b32 s45, s28, 3
    s_add_u32 s45, s45, 28736
    v_add3_u32 v4, v4, v244, s45
    v_and_b32 v244, 7, v2
    v_mul_u32_u24 v5, 2736, v244
    v_mul_u32_u24 v244, 320, v3
    v_lshrrev_b32 v245, 3, v2
    v_lshl_add_u32 v244, v245, 3, v244
    s_lshl_b32 s45, s28, 4
    s_add_u32 s45, s45, 88128
    v_add3_u32 v5, v5, v244, s45
    s_mul_i32 s45, s28, 2736
    s_add_u32 s45, s45, 88128
    v_mul_u32_u24 v244, 160, v2
    v_lshlrev_b32 v245, 4, v3
    v_add_u32 v246, 64, v245
    v_min_u32 v246, 96, v246
    v_add3_u32 v6, v244, v245, s45
    v_add3_u32 v7, v244, v246, s45
    v_sub_u32 v244, 2560, v244
    v_add3_u32 v236, v244, v245, s45
    v_add3_u32 v237, v244, v246, s45
    v_mul_u32_u24 v243, 112, v3
    s_lshl_b32 s45, s28, 4
    v_add_u32 v243, s45, v243
    s_mov_b32 s40, 0
    v_mul_u32_u24 v244, 128, v1
    v_add_u32 v244, s40, v244
    s_mul_i32 s40, s28, 2048
    s_add_u32 s40, s40, 2818048
    s_mov_b32 s39, 131072
    s_mov_b64 vcc, 0xffff
    s_cmp_eq_u32 s28, 7
    s_cbranch_scc1 L_w7a
L_pfb:
    s_mov_b64 exec, vcc
    buffer_load_dword v255, v254, s[12:15], s40 offen sc1
    s_mov_b64 exec, -1
    v_lshrrev_b32 v244, 3, v2
    v_lshlrev_b32 v244, 1, v244
    s_lshl_b32 s59, s28, 2
    v_add_u32 v244, s59, v244
    v_cvt_f32_u32 v244, v244
    v_mul_f32 v244, 0x3b124925, v244
    v_add_f32 v245, 0x3b124925, v244
    v_lshlrev_b32 v246, 1, v3
    v_cvt_f32_u32 v246, v246
    v_mul_f32 v166, v246, v244
    v_mul_f32 v170, v246, v245
    v_add_f32 v247, 0x3f800000, v246
    v_mul_f32 v167, v247, v244
    v_mul_f32 v171, v247, v245
    v_add_f32 v247, 0x41000000, v246
    v_mul_f32 v168, v247, v244
    v_mul_f32 v172, v247, v245
    v_add_f32 v247, 0x41100000, v246
    v_mul_f32 v169, v247, v244
    v_mul_f32 v173, v247, v245
    v_mul_f32 v174, 0x41800000, v244
    v_mul_f32 v175, 0x41800000, v245
    v_cos_f32 v156, v166
    v_cos_f32 v157, v167
    v_cos_f32 v158, v168
    v_cos_f32 v159, v169
    v_cos_f32 v160, v170
    v_cos_f32 v161, v171
    v_cos_f32 v162, v172
    v_cos_f32 v163, v173
    v_cos_f32 v164, v174
    v_cos_f32 v165, v175
    v_sin_f32 v166, v166
    v_sin_f32 v167, v167
    v_sin_f32 v168, v168
    v_sin_f32 v169, v169
    v_sin_f32 v170, v170
    v_sin_f32 v171, v171
    v_sin_f32 v172, v172
    v_sin_f32 v173, v173
    v_sin_f32 v174, v174
    v_sin_f32 v175, v175
    v_mov_b32 v244, v254
    s_mov_b64 exec, 0xffff
    s_branch L_pfcb
L_pflb:
    buffer_load_dword v255, v244, s[12:15], s40 offen sc1
    s_sub_u32 s39, s39, 1
    s_cbranch_scc1 L_pfdb
L_pfcb:
    s_waitcnt vmcnt(0)
    v_cmp_ne_u32 vcc, s63, v255
    s_nop 0
    s_mov_b64 exec, vcc
    s_cbranch_vccz L_pfdb
    s_branch L_pflb
L_pfdb:
    s_mov_b32 exec_lo, 0xffffffff
    s_mov_b32 exec_hi, 0xffffff
    s_add_u32 m0, s43, s46
    s_add_u32 s45, s38, s47
    buffer_load_dwordx4 v242, s[12:15], s45 offen sc1 lds
    s_add_u32 s46, s46, 928
    s_add_u32 s47, s47, 896
    s_cmp_eq_u32 s47, 7168
    s_cselect_b32 s46, 0, s46
    s_cselect_b32 s47, 0, s47
    s_add_u32 m0, s43, s46
    s_add_u32 s45, s38, s47
    buffer_load_dwordx4 v242, s[12:15], s45 offen sc1 lds
    s_add_u32 s46, s46, 928
    s_add_u32 s47, s47, 896
    s_cmp_eq_u32 s47, 7168
    s_cselect_b32 s46, 0, s46
    s_cselect_b32 s47, 0, s47
    s_add_u32 m0, s43, s46
    s_add_u32 s45, s38, s47
    buffer_load_dwordx4 v242, s[12:15], s45 offen sc1 lds
    s_add_u32 s46, s46, 928
    s_add_u32 s47, s47, 896
    s_cmp_eq_u32 s47, 7168
    s_cselect_b32 s46, 0, s46
    s_cselect_b32 s47, 0, s47
    s_add_u32 m0, s43, s46
    s_add_u32 s45, s38, s47
    buffer_load_dwordx4 v242, s[12:15], s45 offen sc1 lds
    s_add_u32 s46, s46, 928
    s_add_u32 s47, s47, 896
    s_cmp_eq_u32 s47, 7168
    s_cselect_b32 s46, 0, s46
    s_cselect_b32 s47, 0, s47
    s_add_u32 m0, s43, s46
    s_add_u32 s45, s38, s47
    buffer_load_dwordx4 v242, s[12:15], s45 offen sc1 lds
    s_add_u32 s46, s46, 928
    s_add_u32 s47, s47, 896
    s_cmp_eq_u32 s47, 7168
    s_cselect_b32 s46, 0, s46
    s_cselect_b32 s47, 0, s47
    s_add_u32 m0, s43, s46
    s_add_u32 s45, s38, s47
    buffer_load_dwordx4 v242, s[12:15], s45 offen sc1 lds
    s_add_u32 s46, s46, 928
    s_add_u32 s47, s47, 896
    s_cmp_eq_u32 s47, 7168
    s_cselect_b32 s46, 0, s46
    s_cselect_b32 s47, 0, s47
    s_add_u32 m0, s43, s46
    s_add_u32 s45, s38, s47
    buffer_load_dwordx4 v242, s[12:15], s45 offen sc1 lds
    s_add_u32 s46, s46, 928
    s_add_u32 s47, s47, 896
    s_cmp_eq_u32 s47, 7168
    s_cselect_b32 s46, 0, s46
    s_cselect_b32 s47, 0, s47
    s_add_u32 m0, s43, s46
    s_add_u32 s45, s38, s47
    buffer_load_dwordx4 v242, s[12:15], s45 offen sc1 lds
    s_mov_b64 exec, -1
    v_lshlrev_b32 v84, 16, v104
    v_and_b32 v85, 0xffff0000, v104
    v_lshlrev_b32 v86, 16, v105
    v_and_b32 v87, 0xffff0000, v105
    v_lshlrev_b32 v88, 16, v106
    v_and_b32 v89, 0xffff0000, v106
    v_lshlrev_b32 v90, 16, v107
    v_and_b32 v91, 0xffff0000, v107
    v_lshlrev_b32 v92, 16, v232
    v_and_b32 v93, 0xffff0000, v232
    v_lshlrev_b32 v94, 16, v233
    v_and_b32 v95, 0xffff0000, v233
    v_lshlrev_b32 v96, 16, v234
    v_and_b32 v97, 0xffff0000, v234
    v_lshlrev_b32 v98, 16, v235
    v_and_b32 v99, 0xffff0000, v235
    s_cmp_eq_u32 s28, 7
    s_cbranch_scc1 L_w7b
L_tw:
L_pardn:
    s_waitcnt vmcnt(0)
L_b1:
    s_barrier
    s_cmp_eq_u32 s28, 7
    s_cbranch_scc1 L_w7par
    ds_read_b64_tr_b16 v[176:177], v4 offset:0
    ds_read_b64_tr_b16 v[178:179], v4 offset:14848
    ds_read_b64_tr_b16 v[180:181], v4 offset:29696
    ds_read_b64_tr_b16 v[182:183], v4 offset:44544
    ds_read_b64_tr_b16 v[184:185], v4 offset:224
    ds_read_b64_tr_b16 v[186:187], v4 offset:15072
    ds_read_b64_tr_b16 v[188:189], v4 offset:29920
    ds_read_b64_tr_b16 v[190:191], v4 offset:44768
    ds_read_b64_tr_b16 v[192:193], v4 offset:448
    ds_read_b64_tr_b16 v[194:195], v4 offset:15296
    ds_read_b64_tr_b16 v[196:197], v4 offset:30144
    ds_read_b64_tr_b16 v[198:199], v4 offset:44992
    s_waitcnt lgkmcnt(8)
    v_mfma_f32_16x16x32_bf16 v[208:211], v[176:179], v[108:111], 0
    v_mfma_f32_16x16x32_bf16 v[208:211], v[180:183], v[112:115], v[208:211]
    ds_read_b64_tr_b16 v[200:201], v4 offset:672
    ds_read_b64_tr_b16 v[202:203], v4 offset:15520
    ds_read_b64_tr_b16 v[204:205], v4 offset:30368
    ds_read_b64_tr_b16 v[206:207], v4 offset:45216
    s_waitcnt lgkmcnt(8)
    v_mfma_f32_16x16x32_bf16 v[212:215], v[184:187], v[108:111], 0
    v_mfma_f32_16x16x32_bf16 v[212:215], v[188:191], v[112:115], v[212:215]
    ds_read_b128 v[8:11], v243 offset:26368
    ds_read_b128 v[12:15], v243 offset:26816
    ds_read_b128 v[16:19], v243 offset:27264
    ds_read_b128 v[20:23], v243 offset:27712
    s_waitcnt lgkmcnt(8)
    v_mfma_f32_16x16x32_bf16 v[216:219], v[192:195], v[108:111], 0
    v_mfma_f32_16x16x32_bf16 v[216:219], v[196:199], v[112:115], v[216:219]
    s_waitcnt lgkmcnt(4)
    v_mfma_f32_16x16x32_bf16 v[220:223], v[200:203], v[108:111], 0
    v_mfma_f32_16x16x32_bf16 v[220:223], v[204:207], v[112:115], v[220:223]
    s_waitcnt lgkmcnt(0)
    v_mul_f32 v208, v208, v8
    v_mul_f32 v209, v209, v9
    v_mul_f32 v210, v210, v10
    v_mul_f32 v211, v211, v11
    v_mul_f32 v212, v212, v12
    v_mul_f32 v213, v213, v13
    v_mul_f32 v214, v214, v14
    v_mul_f32 v215, v215, v15
    v_mul_f32 v216, v216, v16
    v_mul_f32 v217, v217, v17
    v_mul_f32 v218, v218, v18
    v_mul_f32 v219, v219, v19
    v_mul_f32 v220, v220, v20
    v_mul_f32 v221, v221, v21
    v_mul_f32 v222, v222, v22
    v_mul_f32 v223, v223, v23
    s_cmp_eq_u32 s2, 0
    s_cbranch_scc1 L_sa
L_nosa2:
    v_cvt_pk_bf16_f32 v224, v208, v212
    v_cvt_pk_bf16_f32 v226, v210, v214
    v_cvt_pk_bf16_f32 v232, v210, v214
    v_cvt_pk_bf16_f32 v225, v216, v220
    v_cvt_pk_bf16_f32 v227, v218, v222
    v_cvt_pk_bf16_f32 v233, v218, v222
    v_cvt_pk_bf16_f32 v228, v209, v213
    v_cvt_pk_bf16_f32 v230, v211, v215
    v_cvt_pk_bf16_f32 v234, v211, v215
    v_cvt_pk_bf16_f32 v229, v217, v221
    v_cvt_pk_bf16_f32 v231, v219, v223
    v_cvt_pk_bf16_f32 v235, v219, v223
    v_mov_b32_dpp v226, v224 row_ror:8 row_mask:0xf bank_mask:0x3
    v_mov_b32_dpp v227, v225 row_ror:8 row_mask:0xf bank_mask:0x3
    v_mov_b32_dpp v230, v228 row_ror:8 row_mask:0xf bank_mask:0x3
    v_mov_b32_dpp v231, v229 row_ror:8 row_mask:0xf bank_mask:0x3
    v_mov_b32_dpp v224, v232 row_ror:8 row_mask:0xf bank_mask:0xc
    v_mov_b32_dpp v225, v233 row_ror:8 row_mask:0xf bank_mask:0xc
    v_mov_b32_dpp v228, v234 row_ror:8 row_mask:0xf bank_mask:0xc
    v_mov_b32_dpp v229, v235 row_ror:8 row_mask:0xf bank_mask:0xc
    v_mfma_f32_16x16x32_bf16 v[176:179], v[116:119], v[224:227], 0
    v_mfma_f32_16x16x32_bf16 v[180:183], v[120:123], v[224:227], 0
    v_mfma_f32_16x16x32_bf16 v[184:187], v[116:119], v[228:231], 0
    v_mfma_f32_16x16x32_bf16 v[188:191], v[120:123], v[228:231], 0
    s_nop 4
    v_mul_f32 v244, v176, v156
    v_mul_f32 v245, v177, v156
    v_fmac_f32 v244, v177, v166
    v_fma_f32 v245, -v176, v166, v245
    v_cvt_pk_bf16_f32 v192, v244, v245
    v_mul_f32 v246, v184, v160
    v_mul_f32 v247, v185, v160
    v_fmac_f32 v246, v185, v170
    v_fma_f32 v247, -v184, v170, v247
    v_cvt_pk_bf16_f32 v193, v246, v247
    ds_write_b64 v5, v[192:193] offset:0
    v_mul_f32 v248, v178, v157
    v_mul_f32 v249, v179, v157
    v_fmac_f32 v248, v179, v167
    v_fma_f32 v249, -v178, v167, v249
    v_cvt_pk_bf16_f32 v194, v248, v249
    v_mul_f32 v250, v186, v161
    v_mul_f32 v251, v187, v161
    v_fmac_f32 v250, v187, v171
    v_fma_f32 v251, -v186, v171, v251
    v_cvt_pk_bf16_f32 v195, v250, v251
    ds_write_b64 v5, v[194:195] offset:160
    v_mul_f32 v244, v180, v158
    v_mul_f32 v245, v181, v158
    v_fmac_f32 v244, v181, v168
    v_fma_f32 v245, -v180, v168, v245
    v_cvt_pk_bf16_f32 v196, v244, v245
    v_mul_f32 v246, v188, v162
    v_mul_f32 v247, v189, v162
    v_fmac_f32 v246, v189, v172
    v_fma_f32 v247, -v188, v172, v247
    v_cvt_pk_bf16_f32 v197, v246, v247
    ds_write_b64 v5, v[196:197] offset:1280
    v_mul_f32 v248, v182, v159
    v_mul_f32 v249, v183, v159
    v_fmac_f32 v248, v183, v169
    v_fma_f32 v249, -v182, v169, v249
    v_cvt_pk_bf16_f32 v198, v248, v249
    v_mul_f32 v250, v190, v163
    v_mul_f32 v251, v191, v163
    v_fmac_f32 v250, v191, v173
    v_fma_f32 v251, -v190, v173, v251
    v_cvt_pk_bf16_f32 v199, v250, v251
    ds_write_b64 v5, v[198:199] offset:1440
    v_mul_f32 v244, v176, v164
    v_mul_f32 v245, v177, v164
    v_fmac_f32 v244, v177, v174
    v_fma_f32 v245, -v176, v174, v245
    v_cvt_pk_bf16_f32 v200, v244, v245
    v_mul_f32 v246, v184, v165
    v_mul_f32 v247, v185, v165
    v_fmac_f32 v246, v185, v175
    v_fma_f32 v247, -v184, v175, v247
    v_cvt_pk_bf16_f32 v201, v246, v247
    s_mov_b64 exec, 0xffff
    ds_write_b64 v5, v[200:201] offset:2560
    s_mov_b64 exec, -1
L_h2:
    v_mov_b32 v254, 0
    s_waitcnt lgkmcnt(0)
    s_barrier
    ds_read_b128 v[208:211], v6
    ds_read_b128 v[212:215], v7
    ds_read_b128 v[216:219], v236
    ds_read_b128 v[220:223], v237
    ds_read_b128 v[40:43], v242 offset:12288
    ds_read_b128 v[44:47], v242 offset:13312
    ds_read_b128 v[64:67], v242 offset:18432
    ds_read_b128 v[68:71], v242 offset:19456
    ds_read_b64 v[254:255], v254 offset:28704
    s_waitcnt lgkmcnt(8)
    v_mfma_f32_16x16x32_bf16 v[176:179], v[208:211], v[124:127], 0
    v_mfma_f32_16x16x32_bf16 v[180:183], v[208:211], v[132:135], 0
    s_waitcnt lgkmcnt(7)
    v_mfma_f32_16x16x32_bf16 v[176:179], v[212:215], v[128:131], v[176:179]
    v_mfma_f32_16x16x32_bf16 v[180:183], v[212:215], v[136:139], v[180:183]
    s_waitcnt lgkmcnt(6)
    v_mfma_f32_16x16x32_bf16 v[184:187], v[216:219], v[140:143], 0
    v_mfma_f32_16x16x32_bf16 v[188:191], v[216:219], v[148:151], 0
    s_waitcnt lgkmcnt(5)
    v_mfma_f32_16x16x32_bf16 v[184:187], v[220:223], v[144:147], v[184:187]
    v_mfma_f32_16x16x32_bf16 v[188:191], v[220:223], v[152:155], v[188:191]
    s_waitcnt lgkmcnt(1)
    v_fma_f32 v176, v40, v176, v84
    v_fma_f32 v177, v41, v177, v85
    v_fma_f32 v178, v42, v178, v86
    v_fma_f32 v179, v43, v179, v87
    v_fma_f32 v180, v44, v180, v88
    v_fma_f32 v181, v45, v181, v89
    v_fma_f32 v182, v46, v182, v90
    v_fma_f32 v183, v47, v183, v91
    v_mul_f32 v246, v176, v176
    v_mul_f32 v248, v176, v64
    v_add_f32 v244, v176, v177
    v_fmac_f32 v246, v177, v177
    v_fmac_f32 v248, v177, v65
    v_add_f32 v244, v244, v178
    v_fmac_f32 v246, v178, v178
    v_fmac_f32 v248, v178, v66
    v_add_f32 v244, v244, v179
    v_fmac_f32 v246, v179, v179
    v_fmac_f32 v248, v179, v67
    v_add_f32 v244, v244, v180
    v_fmac_f32 v246, v180, v180
    v_fmac_f32 v248, v180, v68
    v_add_f32 v244, v244, v181
    v_fmac_f32 v246, v181, v181
    v_fmac_f32 v248, v181, v69
    v_add_f32 v244, v244, v182
    v_fmac_f32 v246, v182, v182
    v_fmac_f32 v248, v182, v70
    v_add_f32 v244, v244, v183
    v_fmac_f32 v246, v183, v183
    v_fmac_f32 v248, v183, v71
    v_fma_f32 v184, v40, v184, v92
    v_fma_f32 v185, v41, v185, v93
    v_fma_f32 v186, v42, v186, v94
    v_fma_f32 v187, v43, v187, v95
    v_fma_f32 v188, v44, v188, v96
    v_fma_f32 v189, v45, v189, v97
    v_fma_f32 v190, v46, v190, v98
    v_fma_f32 v191, v47, v191, v99
    v_mul_f32 v247, v184, v184
    v_mul_f32 v249, v184, v64
    v_add_f32 v245, v184, v185
    v_fmac_f32 v247, v185, v185
    v_fmac_f32 v249, v185, v65
    v_add_f32 v245, v245, v186
    v_fmac_f32 v247, v186, v186
    v_fmac_f32 v249, v186, v66
    v_add_f32 v245, v245, v187
    v_fmac_f32 v247, v187, v187
    v_fmac_f32 v249, v187, v67
    v_add_f32 v245, v245, v188
    v_fmac_f32 v247, v188, v188
    v_fmac_f32 v249, v188, v68
    v_add_f32 v245, v245, v189
    v_fmac_f32 v247, v189, v189
    v_fmac_f32 v249, v189, v69
    v_add_f32 v245, v245, v190
    v_fmac_f32 v247, v190, v190
    v_fmac_f32 v249, v190, v70
    v_add_f32 v245, v245, v191
    v_fmac_f32 v247, v191, v191
    v_fmac_f32 v249, v191, v71
    v_permlane32_swap_b32 v244, v245
    v_permlane32_swap_b32 v246, v247
    v_permlane32_swap_b32 v248, v249
    v_add_f32 v244, v244, v245
    v_add_f32 v246, v246, v247
    v_add_f32 v248, v248, v249
    v_add_f32_dpp v244, v244, v244 row_ror:8 row_mask:0xf bank_mask:0xf
    v_add_f32_dpp v246, v246, v246 row_ror:8 row_mask:0xf bank_mask:0xf
    v_add_f32_dpp v248, v248, v248 row_ror:8 row_mask:0xf bank_mask:0xf
    v_add_f32_dpp v244, v244, v244 row_ror:4 row_mask:0xf bank_mask:0xf
    v_add_f32_dpp v246, v246, v246 row_ror:4 row_mask:0xf bank_mask:0xf
    v_add_f32_dpp v248, v248, v248 row_ror:4 row_mask:0xf bank_mask:0xf
    v_add_f32_dpp v244, v244, v244 row_ror:2 row_mask:0xf bank_mask:0xf
    v_add_f32_dpp v246, v246, v246 row_ror:2 row_mask:0xf bank_mask:0xf
    v_add_f32_dpp v248, v248, v248 row_ror:2 row_mask:0xf bank_mask:0xf
    v_add_f32_dpp v244, v244, v244 row_ror:1 row_mask:0xf bank_mask:0xf
    v_add_f32_dpp v246, v246, v246 row_ror:1 row_mask:0xf bank_mask:0xf
    v_add_f32_dpp v248, v248, v248 row_ror:1 row_mask:0xf bank_mask:0xf
    v_add_f32_dpp v244, v244, v244 row_bcast:15 row_mask:0xa bank_mask:0xf
    v_add_f32_dpp v246, v246, v246 row_bcast:15 row_mask:0xa bank_mask:0xf
    v_add_f32_dpp v248, v248, v248 row_bcast:15 row_mask:0xa bank_mask:0xf
    v_mul_f32 v244, 0x3b124925, v244
    v_mul_f32 v246, 0x3b124925, v246
    v_fma_f32 v246, -v244, v244, v246
    v_max_f32 v246, 0, v246
    v_cvt_pk_bf16_f32 v245, v244, v246
    v_lshlrev_b32 v244, 16, v245
    v_and_b32 v246, 0xffff0000, v245
    v_add_f32 v246, 0x3727c5ac, v246
    v_cvt_pk_bf16_f32 v246, v246, v246
    v_lshlrev_b32 v246, 16, v246
    v_sqrt_f32 v246, v246
    s_waitcnt lgkmcnt(0)
    v_fma_f32 v248, -v244, v255, v248
    v_cvt_pk_bf16_f32 v246, v246, v246
    v_lshlrev_b32 v246, 16, v246
    v_rcp_f32 v246, v246
    s_nop 0
    v_fma_f32 v248, v248, v246, v254
    v_mul_f32 v245, -v244, v246
    v_ashrrev_i32 v249, 31, v248
    v_or_b32 v249, 0x80000000, v249
    v_xor_b32 v248, v248, v249
    v_and_b32 v248, 0xfffff800, v248
    v_min_u32 v248, 0xfffff000, v248
    v_readlane_b32 s52, v246, 16
    v_readlane_b32 s56, v248, 16
    v_readlane_b32 s57, v248, 48
    v_readlane_b32 s53, v245, 16
    s_or_b32 s56, s56, s36
    s_or_b32 s57, s57, s37
    s_cmp_eq_u32 s36, s37
    s_cselect_b32 s57, 0, s57
    s_max_u32 s56, s56, s57
    v_mov_b32 v250, s56
    v_mov_b32 v251, 0
    v_mov_b32 v249, 1
    s_mov_b64 exec, 1
    ds_max_u32 v251, v250 offset:28672
    ds_add_rtn_u32 v249, v251, v249 offset:28676
    ds_read_b32 v250, v251 offset:28672
    s_mov_b64 exec, -1
    v_readlane_b32 s54, v246, 48
    v_readlane_b32 s55, v245, 48
    v_mov_b32 v252, s53
    s_mul_i32 s61, s2, 1792
    s_add_u32 s61, s61, 2162688
    s_lshl_b32 s62, s2, 7
    s_add_u32 s62, s62, 2654208
    v_mov_b32 v253, s55
    v_mul_u32_u24 v248, 18432, v1
    s_waitcnt lgkmcnt(0)
    v_readfirstlane_b32 s58, v249
    v_readfirstlane_b32 s59, v250
    s_cmp_lg_u32 s58, 7
    s_cbranch_scc1 L_notlast
    v_mov_b32 v246, s59
    v_mov_b32 v247, s63
    s_mov_b64 exec, 0xf
    buffer_store_dwordx2 v[246:247], v248, s[12:15], s62 offen sc1
    s_mov_b64 exec, -1
L_notlast:
    s_barrier
    ds_read_b32 v244, v251 offset:28672
    ds_read_b128 v[48:51], v242 offset:14336
    ds_read_b128 v[52:55], v242 offset:15360
    ds_read_b128 v[56:59], v242 offset:16384
    ds_read_b128 v[60:63], v242 offset:17408
    v_fma_f32 v208, v176, s52, v252
    v_fma_f32 v209, v177, s52, v252
    v_fma_f32 v210, v178, s52, v252
    v_fma_f32 v211, v179, s52, v252
    v_fma_f32 v212, v180, s52, v252
    v_fma_f32 v213, v181, s52, v252
    v_fma_f32 v214, v182, s52, v252
    v_fma_f32 v215, v183, s52, v252
    v_fma_f32 v216, v184, s54, v253
    v_fma_f32 v217, v185, s54, v253
    v_fma_f32 v218, v186, s54, v253
    v_fma_f32 v219, v187, s54, v253
    v_fma_f32 v220, v188, s54, v253
    v_fma_f32 v221, v189, s54, v253
    v_fma_f32 v222, v190, s54, v253
    v_fma_f32 v223, v191, s54, v253
    s_waitcnt lgkmcnt(4)
    v_readfirstlane_b32 s59, v244
    s_nop 0
    s_cmp_lg_u32 s59, s56
    s_waitcnt lgkmcnt(0)
    s_cbranch_scc1 L_nokey
    ds_read_b128 v[8:11], v242 offset:20480
    ds_read_b128 v[12:15], v242 offset:21504
    ds_read_b128 v[16:19], v242 offset:22528
    ds_read_b128 v[20:23], v242 offset:23552
L_nokey:
    s_and_b32 s60, s59, 0x7ff
    v_add_f32 v176, v176, v48
    v_add_f32 v177, v177, v49
    v_add_f32 v178, v178, v50
    v_add_f32 v179, v179, v51
    v_add_f32 v180, v180, v52
    v_add_f32 v181, v181, v53
    v_add_f32 v182, v182, v54
    v_add_f32 v183, v183, v55
    v_fmac_f32 v176, v208, v56
    v_fmac_f32 v177, v209, v57
    v_fmac_f32 v178, v210, v58
    v_fmac_f32 v179, v211, v59
    v_fmac_f32 v180, v212, v60
    v_fmac_f32 v181, v213, v61
    v_fmac_f32 v182, v214, v62
    v_fmac_f32 v183, v215, v63
    v_cvt_pk_bf16_f32 v224, v176, v177
    v_cvt_pk_bf16_f32 v225, v178, v179
    v_cvt_pk_bf16_f32 v226, v180, v181
    v_cvt_pk_bf16_f32 v227, v182, v183
    s_cmp_eq_u32 s36, s60
    s_cbranch_scc1 L_pub0
    buffer_store_dwordx2 v[224:225], v240, s[20:23], s41 offen sc1
    buffer_store_dwordx2 v[226:227], v241, s[20:23], s41 offen sc1
    s_branch L_row1
L_pub0:
    s_waitcnt lgkmcnt(0)
    v_fma_f32 v24, v208, v8, v16
    v_fma_f32 v25, v209, v9, v17
    v_fma_f32 v26, v210, v10, v18
    v_fma_f32 v27, v211, v11, v19
    v_fma_f32 v28, v212, v12, v20
    v_fma_f32 v29, v213, v13, v21
    v_fma_f32 v30, v214, v14, v22
    v_fma_f32 v31, v215, v15, v23
    v_cvt_pk_bf16_f32 v246, v24, v25
    v_min_u32 v246, -2, v246
    v_cvt_pk_bf16_f32 v247, v26, v27
    v_min_u32 v247, -2, v247
    v_cvt_pk_bf16_f32 v248, v28, v29
    v_min_u32 v248, -2, v248
    v_cvt_pk_bf16_f32 v249, v30, v31
    v_min_u32 v249, -2, v249
    buffer_store_dwordx2 v[246:247], v240, s[12:15], s61 offen sc1
    buffer_store_dwordx2 v[248:249], v241, s[12:15], s61 offen sc1
    v_min_u32 v224, -2, v224
    v_min_u32 v225, -2, v225
    v_min_u32 v226, -2, v226
    v_min_u32 v227, -2, v227
    buffer_store_dwordx2 v[224:225], v240, s[12:15], s61 offen offset:896 sc1
    buffer_store_dwordx2 v[226:227], v241, s[12:15], s61 offen offset:896 sc1
L_row1:
    s_cmp_eq_u32 s36, s37
    s_cbranch_scc1 L_fin
    v_add_f32 v184, v184, v48
    v_add_f32 v185, v185, v49
    v_add_f32 v186, v186, v50
    v_add_f32 v187, v187, v51
    v_add_f32 v188, v188, v52
    v_add_f32 v189, v189, v53
    v_add_f32 v190, v190, v54
    v_add_f32 v191, v191, v55
    v_fmac_f32 v184, v216, v56
    v_fmac_f32 v185, v217, v57
    v_fmac_f32 v186, v218, v58
    v_fmac_f32 v187, v219, v59
    v_fmac_f32 v188, v220, v60
    v_fmac_f32 v189, v221, v61
    v_fmac_f32 v190, v222, v62
    v_fmac_f32 v191, v223, v63
    v_cvt_pk_bf16_f32 v228, v184, v185
    v_cvt_pk_bf16_f32 v229, v186, v187
    v_cvt_pk_bf16_f32 v230, v188, v189
    v_cvt_pk_bf16_f32 v231, v190, v191
    s_cmp_eq_u32 s37, s60
    s_cbranch_scc1 L_pub1
    buffer_store_dwordx2 v[228:229], v240, s[20:23], s42 offen sc1
    buffer_store_dwordx2 v[230:231], v241, s[20:23], s42 offen sc1
    s_branch L_fin
L_pub1:
    s_waitcnt lgkmcnt(0)
    v_fma_f32 v24, v216, v8, v16
    v_fma_f32 v25, v217, v9, v17
    v_fma_f32 v26, v218, v10, v18
    v_fma_f32 v27, v219, v11, v19
    v_fma_f32 v28, v220, v12, v20
    v_fma_f32 v29, v221, v13, v21
    v_fma_f32 v30, v222, v14, v22
    v_fma_f32 v31, v223, v15, v23
    v_cvt_pk_bf16_f32 v246, v24, v25
    v_min_u32 v246, -2, v246
    v_cvt_pk_bf16_f32 v247, v26, v27
    v_min_u32 v247, -2, v247
    v_cvt_pk_bf16_f32 v248, v28, v29
    v_min_u32 v248, -2, v248
    v_cvt_pk_bf16_f32 v249, v30, v31
    v_min_u32 v249, -2, v249
    buffer_store_dwordx2 v[246:247], v240, s[12:15], s61 offen sc1
    buffer_store_dwordx2 v[248:249], v241, s[12:15], s61 offen sc1
    v_min_u32 v228, -2, v228
    v_min_u32 v229, -2, v229
    v_min_u32 v230, -2, v230
    v_min_u32 v231, -2, v231
    buffer_store_dwordx2 v[228:229], v240, s[12:15], s61 offen offset:896 sc1
    buffer_store_dwordx2 v[230:231], v241, s[12:15], s61 offen offset:896 sc1
    s_branch L_fin
L_w7a:
    buffer_load_dwordx2 v[40:41], v240, s[24:27], 0 offen
    buffer_load_dwordx2 v[42:43], v241, s[24:27], 0 offen
L_pf7b:
    s_mov_b64 exec, s[66:67]
    buffer_load_dword v247, v244, s[12:15], s64 offen sc1
    s_mov_b64 exec, s[68:69]
    buffer_load_dword v246, v244, s[12:15], s44 offen sc1
    s_mov_b64 exec, vcc
    buffer_load_dword v245, v244, s[12:15], s40 offen sc1
    s_sub_u32 s39, s39, 1
    s_cbranch_scc1 L_pfdb
    s_waitcnt vmcnt(0)
    v_cmp_ne_u32 vcc, s63, v245
    s_mov_b64 exec, s[68:69]
    v_cmp_ne_u32 s[68:69], s63, v246
    s_mov_b64 exec, s[66:67]
    v_cmp_ne_u32 s[66:67], s63, v247
    s_mov_b64 exec, -1
    s_cbranch_vccz L_pfdb
    s_and_b32 s45, s65, 1
    s_or_b32 s45, s45, s66
    s_cbranch_scc1 L_pf7bb
    s_or_b32 s65, s65, 1
    s_mov_b32 m0, 24576
    s_mov_b32 s45, 2097152
    buffer_load_dwordx4 v242, s[12:15], s45 offen sc1 lds
    s_mov_b32 m0, 25600
    s_mov_b32 s45, 2098176
    buffer_load_dwordx4 v242, s[12:15], s45 offen sc1 lds
    s_mov_b32 m0, 26624
    s_mov_b32 s45, 2099200
    buffer_load_dwordx4 v242, s[12:15], s45 offen sc1 lds
    s_mov_b32 m0, 27648
    s_mov_b32 s45, 2100224
    s_mov_b32 exec_hi, 0
    buffer_load_dwordx4 v242, s[12:15], s45 offen sc1 lds
    s_mov_b32 exec_hi, -1
L_pf7bb:
    s_and_b32 s45, s65, 2
    s_or_b32 s45, s45, s68
    s_or_b32 s45, s45, s69
    s_cbranch_scc1 L_pf7b
    s_or_b32 s65, s65, 2
    s_mov_b32 s45, 2100736
    buffer_load_dwordx4 v[8:11], v238, s[12:15], s45 offen sc1
    buffer_load_dwordx4 v[12:15], v239, s[12:15], s45 offen sc1
    s_mov_b32 s45, 2102528
    buffer_load_dwordx4 v[16:19], v238, s[12:15], s45 offen sc1
    buffer_load_dwordx4 v[20:23], v239, s[12:15], s45 offen sc1
    s_mov_b32 s45, 2104320
    buffer_load_dwordx4 v[24:27], v238, s[12:15], s45 offen sc1
    buffer_load_dwordx4 v[28:31], v239, s[12:15], s45 offen sc1
    s_mov_b32 s45, 2106112
    buffer_load_dwordx4 v[32:35], v238, s[12:15], s45 offen sc1
    buffer_load_dwordx4 v[36:39], v239, s[12:15], s45 offen sc1
    s_branch L_pf7b
L_w7b:
    s_bitcmp1_b32 s65, 0
    s_cbranch_scc1 L_caok
    s_mov_b32 s39, 131072
    s_cmp_eq_u64 s[66:67], 0
    s_cbranch_scc1 L_pkdca
L_pkca:
    s_mov_b64 exec, s[66:67]
    buffer_load_dword v246, v244, s[12:15], s64 offen sc1
    s_sub_u32 s39, s39, 1
    s_cbranch_scc1 L_pkdca
    s_waitcnt vmcnt(0)
    v_cmp_ne_u32 s[66:67], s63, v246
    s_nop 0
    s_cmp_lg_u64 s[66:67], 0
    s_cbranch_scc1 L_pkca
L_pkdca:
    s_mov_b64 exec, -1
    s_mov_b32 m0, 24576
    s_mov_b32 s45, 2097152
    buffer_load_dwordx4 v242, s[12:15], s45 offen sc1 lds
    s_mov_b32 m0, 25600
    s_mov_b32 s45, 2098176
    buffer_load_dwordx4 v242, s[12:15], s45 offen sc1 lds
    s_mov_b32 m0, 26624
    s_mov_b32 s45, 2099200
    buffer_load_dwordx4 v242, s[12:15], s45 offen sc1 lds
    s_mov_b32 m0, 27648
    s_mov_b32 s45, 2100224
    s_mov_b32 exec_hi, 0
    buffer_load_dwordx4 v242, s[12:15], s45 offen sc1 lds
    s_mov_b32 exec_hi, -1
L_caok:
    s_and_b32 s45, s65, 2
    s_or_b32 s45, s45, s68
    s_or_b32 s45, s45, s69
    s_cbranch_scc1 L_pardn
    s_or_b32 s65, s65, 2
    s_mov_b32 s45, 2100736
    buffer_load_dwordx4 v[8:11], v238, s[12:15], s45 offen sc1
    buffer_load_dwordx4 v[12:15], v239, s[12:15], s45 offen sc1
    s_mov_b32 s45, 2102528
    buffer_load_dwordx4 v[16:19], v238, s[12:15], s45 offen sc1
    buffer_load_dwordx4 v[20:23], v239, s[12:15], s45 offen sc1
    s_mov_b32 s45, 2104320
    buffer_load_dwordx4 v[24:27], v238, s[12:15], s45 offen sc1
    buffer_load_dwordx4 v[28:31], v239, s[12:15], s45 offen sc1
    s_mov_b32 s45, 2106112
    buffer_load_dwordx4 v[32:35], v238, s[12:15], s45 offen sc1
    buffer_load_dwordx4 v[36:39], v239, s[12:15], s45 offen sc1
    s_waitcnt vmcnt(8)
    s_branch L_b1
L_sa:
    ds_read_b128 v[24:27], v243 offset:24576
    ds_read_b128 v[28:31], v243 offset:25024
    ds_read_b128 v[32:35], v243 offset:25472
    ds_read_b128 v[36:39], v243 offset:25920
    v_cmp_eq_u32 vcc, 0, v2
    v_mov_b32 v244, 0x45000000
    s_nop 0
    v_cndmask_b32 v244, 0, v244, vcc
    s_waitcnt lgkmcnt(0)
    v_fmac_f32 v208, v24, v244
    v_fmac_f32 v209, v25, v244
    v_fmac_f32 v210, v26, v244
    v_fmac_f32 v211, v27, v244
    v_fmac_f32 v212, v28, v244
    v_fmac_f32 v213, v29, v244
    v_fmac_f32 v214, v30, v244
    v_fmac_f32 v215, v31, v244
    v_fmac_f32 v216, v32, v244
    v_fmac_f32 v217, v33, v244
    v_fmac_f32 v218, v34, v244
    v_fmac_f32 v219, v35, v244
    v_fmac_f32 v220, v36, v244
    v_fmac_f32 v221, v37, v244
    v_fmac_f32 v222, v38, v244
    v_fmac_f32 v223, v39, v244
    s_branch L_nosa2
L_w7par:
    s_bitcmp1_b32 s65, 1
    s_cbranch_scc1 L_parok
    s_mov_b32 s39, 131072
    s_cmp_eq_u64 s[68:69], 0
    s_cbranch_scc1 L_pkdpar
L_pkpar:
    s_mov_b64 exec, s[68:69]
    buffer_load_dword v246, v244, s[12:15], s44 offen sc1
    s_sub_u32 s39, s39, 1
    s_cbranch_scc1 L_pkdpar
    s_waitcnt vmcnt(0)
    v_cmp_ne_u32 s[68:69], s63, v246
    s_nop 0
    s_cmp_lg_u64 s[68:69], 0
    s_cbranch_scc1 L_pkpar
L_pkdpar:
    s_mov_b64 exec, -1
    s_mov_b32 s45, 2100736
    buffer_load_dwordx4 v[8:11], v238, s[12:15], s45 offen sc1
    buffer_load_dwordx4 v[12:15], v239, s[12:15], s45 offen sc1
    s_mov_b32 s45, 2102528
    buffer_load_dwordx4 v[16:19], v238, s[12:15], s45 offen sc1
    buffer_load_dwordx4 v[20:23], v239, s[12:15], s45 offen sc1
    s_mov_b32 s45, 2104320
    buffer_load_dwordx4 v[24:27], v238, s[12:15], s45 offen sc1
    buffer_load_dwordx4 v[28:31], v239, s[12:15], s45 offen sc1
    s_mov_b32 s45, 2106112
    buffer_load_dwordx4 v[32:35], v238, s[12:15], s45 offen sc1
    buffer_load_dwordx4 v[36:39], v239, s[12:15], s45 offen sc1
L_parok:
    s_waitcnt vmcnt(0)
    v_lshlrev_b32 v244, 16, v40
    v_mul_f32 v64, v24, v244
    v_mul_f32 v48, v32, v16
    v_mul_f32 v56, v32, v24
    v_mul_f32 v246, v16, v244
    v_mov_b32 v245, v64
    v_and_b32 v244, 0xffff0000, v40
    v_mul_f32 v65, v25, v244
    v_mul_f32 v49, v33, v17
    v_mul_f32 v57, v33, v25
    v_fmac_f32 v246, v17, v244
    v_add_f32 v245, v245, v65
    v_lshlrev_b32 v244, 16, v41
    v_mul_f32 v66, v26, v244
    v_mul_f32 v50, v34, v18
    v_mul_f32 v58, v34, v26
    v_fmac_f32 v246, v18, v244
    v_add_f32 v245, v245, v66
    v_and_b32 v244, 0xffff0000, v41
    v_mul_f32 v67, v27, v244
    v_mul_f32 v51, v35, v19
    v_mul_f32 v59, v35, v27
    v_fmac_f32 v246, v19, v244
    v_add_f32 v245, v245, v67
    v_lshlrev_b32 v244, 16, v42
    v_mul_f32 v68, v28, v244
    v_mul_f32 v52, v36, v20
    v_mul_f32 v60, v36, v28
    v_fmac_f32 v246, v20, v244
    v_add_f32 v245, v245, v68
    v_and_b32 v244, 0xffff0000, v42
    v_mul_f32 v69, v29, v244
    v_mul_f32 v53, v37, v21
    v_mul_f32 v61, v37, v29
    v_fmac_f32 v246, v21, v244
    v_add_f32 v245, v245, v69
    v_lshlrev_b32 v244, 16, v43
    v_mul_f32 v70, v30, v244
    v_mul_f32 v54, v38, v22
    v_mul_f32 v62, v38, v30
    v_fmac_f32 v246, v22, v244
    v_add_f32 v245, v245, v70
    v_and_b32 v244, 0xffff0000, v43
    v_mul_f32 v71, v31, v244
    v_mul_f32 v55, v39, v23
    v_mul_f32 v63, v39, v31
    v_fmac_f32 v246, v23, v244
    v_add_f32 v245, v245, v71
    ds_write_b128 v242, v[8:11] offset:12288
    ds_write_b128 v242, v[12:15] offset:13312
    ds_write_b128 v242, v[48:51] offset:14336
    ds_write_b128 v242, v[52:55] offset:15360
    ds_write_b128 v242, v[56:59] offset:16384
    ds_write_b128 v242, v[60:63] offset:17408
    ds_write_b128 v242, v[64:67] offset:18432
    ds_write_b128 v242, v[68:71] offset:19456
    ds_write_b128 v242, v[24:27] offset:20480
    ds_write_b128 v242, v[28:31] offset:21504
    ds_write_b128 v242, v[16:19] offset:22528
    ds_write_b128 v242, v[20:23] offset:23552
    v_add_f32_dpp v245, v245, v245 row_ror:8 row_mask:0xf bank_mask:0xf
    v_add_f32_dpp v246, v246, v246 row_ror:8 row_mask:0xf bank_mask:0xf
    s_nop 0
    v_add_f32_dpp v245, v245, v245 row_ror:4 row_mask:0xf bank_mask:0xf
    v_add_f32_dpp v246, v246, v246 row_ror:4 row_mask:0xf bank_mask:0xf
    s_nop 0
    v_add_f32_dpp v245, v245, v245 row_ror:2 row_mask:0xf bank_mask:0xf
    v_add_f32_dpp v246, v246, v246 row_ror:2 row_mask:0xf bank_mask:0xf
    s_nop 0
    v_add_f32_dpp v245, v245, v245 row_ror:1 row_mask:0xf bank_mask:0xf
    v_add_f32_dpp v246, v246, v246 row_ror:1 row_mask:0xf bank_mask:0xf
    s_nop 0
    v_add_f32_dpp v245, v245, v245 row_bcast:15 row_mask:0xa bank_mask:0xf
    v_add_f32_dpp v246, v246, v246 row_bcast:15 row_mask:0xa bank_mask:0xf
    s_nop 0
    v_add_f32_dpp v245, v245, v245 row_bcast:31 row_mask:0xc bank_mask:0xf
    v_add_f32_dpp v246, v246, v246 row_bcast:31 row_mask:0xc bank_mask:0xf
    v_mov_b32 v244, 0
    v_mov_b32 v247, v245
    s_mov_b32 exec_lo, 0x0
    s_mov_b32 exec_hi, 0x80000000
    ds_write_b64 v244, v[246:247] offset:28704
    s_mov_b64 exec, -1
    s_branch L_h2
L_skipA:
    s_waitcnt lgkmcnt(0)
    s_mov_b32 s2, 128
    s_lshr_b32 s28, s28, 6
    s_mov_b32 s10, 1835008
    s_mov_b32 s11, 0x00020000
    s_mov_b64 s[6:7], s[62:63]
    s_mov_b64 s[16:17], s[58:59]
    s_mov_b32 s12, s6
    s_and_b32 s13, s7, 0xffff
    s_mov_b32 s14, 4194304
    s_mov_b32 s15, 0x00020000
    s_mov_b32 s62, 2109440
    s_load_dword s63, s[6:7], s62
    v_and_b32 v4, 15, v0
    v_bfe_u32 v5, v0, 4, 2
    s_load_dwordx2 s[18:19], s[0:1], 48
    v_and_b32 v242, 63, v0
    v_lshlrev_b32 v242, 4, v242
    s_and_b32 s29, s2, 3
    s_bfe_u32 s35, s2, 196612
    s_lshl_b32 s35, s35, 2
    s_add_u32 s29, s29, s35
    s_bfe_u32 s35, s2, 131074
    s_lshl_b32 s30, s35, 9
    s_add_u32 s30, s30, s29
    s_mov_b32 s55, 64
    s_mov_b32 s32, 1.0
    s_mov_b32 s56, 1.0
    s_mov_b32 s54, 0
    s_cmp_lg_u32 s29, 0
    s_cbranch_scc1 L_ids_donex
    s_mov_b32 s56, 0
    s_cmp_lt_u32 s35, 2
    s_cbranch_scc1 L_mode1x
    s_sub_u32 s30, s30, 992
    s_mov_b32 s32, 0
    s_mov_b32 s54, 1.0
L_mode1x:
    s_cmp_lg_u32 s2, 128
    s_cbranch_scc1 L_ids_donex
    s_movk_i32 s30, 1024
    s_mov_b32 s55, 0
L_ids_donex:
    s_mul_i32 s36, s55, s28
    s_add_u32 s36, s36, s30
    s_sub_u32 s57, 2048, s36
    s_and_b32 s57, s57, 2047
    s_mul_i32 s41, s36, 896
    s_mul_i32 s42, s57, 896
    v_lshlrev_b32 v240, 5, v4
    v_lshl_add_u32 v240, v5, 3, v240
    v_add_u32 v241, 512, v240
    v_cmp_gt_u32 vcc, 12, v4
    v_mov_b32 v243, 0x20000000
    s_nop 0
    v_cndmask_b32 v241, v243, v241, vcc
    buffer_load_dwordx2 v[104:105], v240, s[8:11], s41 offen
    buffer_load_dwordx2 v[106:107], v241, s[8:11], s41 offen
    buffer_load_dwordx2 v[232:233], v240, s[8:11], s42 offen
    buffer_load_dwordx2 v[234:235], v241, s[8:11], s42 offen
    s_waitcnt lgkmcnt(0)
    s_mul_i32 s63, s63, 1664525
    s_add_u32 s63, s63, 1013904223
    v_mov_b32 v40, 0
    v_mov_b32 v41, 0
    s_mov_b32 s34, 0x40000000
    s_branch L_joinA
L_nomod:
    v_and_b32 v100, 63, v0
    v_lshrrev_b32 v101, 1, v100
    v_mul_u32_u24 v101, 3584, v101
    v_and_b32 v102, 1, v100
    v_lshl_add_u32 v101, v102, 4, v101
    s_and_b32 s32, s28, 3
    s_mul_i32 s33, s32, 114688
    s_lshl_b32 s34, s29, 5
    s_add_u32 s33, s33, s34
    s_lshl_b32 s34, s32, 10
    s_add_u32 s34, s34, 4096
    s_add_u32 s36, s34, 14352
    s_cmp_ge_u32 s28, 4
    s_cselect_b32 s34, s36, s34
    s_cselect_b32 s30, s18, s30
    s_cselect_b32 s31, s19, s31
    s_mov_b32 s52, s30
    s_and_b32 s53, s31, 0xffff
    s_mov_b32 s54, 1605632
    s_mov_b32 s55, 0x00020000
    s_mov_b32 s20, s40
    s_and_b32 s21, s41, 0xffff
    s_mov_b32 s22, 1605632
    s_mov_b32 s23, 0x00020000
    s_waitcnt lgkmcnt(0)
    s_mov_b64 s[30:31], s[42:43]
    s_mul_i32 s63, s63, 1664525
    s_add_u32 s63, s63, 1013904223
    s_cmp_ge_u32 s39, 3
    s_cbranch_scc1 L_mlp2
    s_waitcnt vmcnt(4)
    v_lshlrev_b32 v70, 16, v70
    v_mul_f32 v84, 0xbfb8aa3b, v70
    v_exp_f32 v84, v84
    s_nop 0
    v_add_f32 v84, 1.0, v84
    v_rcp_f32 v84, v84
    s_nop 0
    v_mul_f32 v70, v70, v84
    v_cvt_pk_bf16_f32 v70, v70, v70
    v_lshlrev_b32 v70, 16, v70
    v_lshlrev_b32 v71, 16, v71
    v_mul_f32 v84, 0xbfb8aa3b, v71
    v_exp_f32 v84, v84
    s_nop 0
    v_add_f32 v84, 1.0, v84
    v_rcp_f32 v84, v84
    s_nop 0
    v_mul_f32 v71, v71, v84
    v_cvt_pk_bf16_f32 v71, v71, v71
    v_lshlrev_b32 v71, 16, v71
    v_lshlrev_b32 v72, 16, v72
    v_mul_f32 v84, 0xbfb8aa3b, v72
    v_exp_f32 v84, v84
    s_nop 0
    v_add_f32 v84, 1.0, v84
    v_rcp_f32 v84, v84
    s_nop 0
    v_mul_f32 v72, v72, v84
    v_cvt_pk_bf16_f32 v72, v72, v72
    v_lshlrev_b32 v72, 16, v72
    v_lshlrev_b32 v73, 16, v73
    v_mul_f32 v84, 0xbfb8aa3b, v73
    v_exp_f32 v84, v84
    s_nop 0
    v_add_f32 v84, 1.0, v84
    v_rcp_f32 v84, v84
    s_nop 0
    v_mul_f32 v73, v73, v84
    v_cvt_pk_bf16_f32 v73, v73, v73
    v_lshlrev_b32 v73, 16, v73
    s_waitcnt vmcnt(3)
    v_lshlrev_b32 v84, 16, v8
    v_and_b32 v85, 0xffff0000, v8
    v_mul_f32 v86, v84, v70
    v_mul_f32 v87, v85, v70
    v_lshlrev_b32 v84, 16, v9
    v_and_b32 v85, 0xffff0000, v9
    v_mul_f32 v88, v84, v70
    v_mul_f32 v89, v85, v70
    v_lshlrev_b32 v84, 16, v10
    v_and_b32 v85, 0xffff0000, v10
    v_mul_f32 v90, v84, v70
    v_mul_f32 v91, v85, v70
    v_lshlrev_b32 v84, 16, v11
    v_and_b32 v85, 0xffff0000, v11
    v_mul_f32 v92, v84, v70
    v_mul_f32 v93, v85, v70
    s_waitcnt vmcnt(2)
    v_lshlrev_b32 v84, 16, v12
    v_and_b32 v85, 0xffff0000, v12
    v_fmac_f32 v86, v84, v71
    v_fmac_f32 v87, v85, v71
    v_lshlrev_b32 v84, 16, v13
    v_and_b32 v85, 0xffff0000, v13
    v_fmac_f32 v88, v84, v71
    v_fmac_f32 v89, v85, v71
    v_lshlrev_b32 v84, 16, v14
    v_and_b32 v85, 0xffff0000, v14
    v_fmac_f32 v90, v84, v71
    v_fmac_f32 v91, v85, v71
    v_lshlrev_b32 v84, 16, v15
    v_and_b32 v85, 0xffff0000, v15
    v_fmac_f32 v92, v84, v71
    v_fmac_f32 v93, v85, v71
    s_waitcnt vmcnt(1)
    v_lshlrev_b32 v84, 16, v16
    v_and_b32 v85, 0xffff0000, v16
    v_fmac_f32 v86, v84, v72
    v_fmac_f32 v87, v85, v72
    v_lshlrev_b32 v84, 16, v17
    v_and_b32 v85, 0xffff0000, v17
    v_fmac_f32 v88, v84, v72
    v_fmac_f32 v89, v85, v72
    v_lshlrev_b32 v84, 16, v18
    v_and_b32 v85, 0xffff0000, v18
    v_fmac_f32 v90, v84, v72
    v_fmac_f32 v91, v85, v72
    v_lshlrev_b32 v84, 16, v19
    v_and_b32 v85, 0xffff0000, v19
    v_fmac_f32 v92, v84, v72
    v_fmac_f32 v93, v85, v72
    s_waitcnt vmcnt(0)
    v_lshlrev_b32 v84, 16, v20
    v_and_b32 v85, 0xffff0000, v20
    v_fmac_f32 v86, v84, v73
    v_fmac_f32 v87, v85, v73
    v_lshlrev_b32 v84, 16, v21
    v_and_b32 v85, 0xffff0000, v21
    v_fmac_f32 v88, v84, v73
    v_fmac_f32 v89, v85, v73
    v_lshlrev_b32 v84, 16, v22
    v_and_b32 v85, 0xffff0000, v22
    v_fmac_f32 v90, v84, v73
    v_fmac_f32 v91, v85, v73
    v_lshlrev_b32 v84, 16, v23
    v_and_b32 v85, 0xffff0000, v23
    v_fmac_f32 v92, v84, v73
    v_fmac_f32 v93, v85, v73
    v_permlane32_swap_b32 v86, v90
    v_permlane32_swap_b32 v87, v91
    v_permlane32_swap_b32 v88, v92
    v_permlane32_swap_b32 v89, v93
    v_add_f32 v86, v86, v90
    v_add_f32 v87, v87, v91
    v_add_f32 v88, v88, v92
    v_add_f32 v89, v89, v93
    s_nop 0
    v_permlane16_swap_b32 v86, v88
    v_permlane16_swap_b32 v87, v89
    v_add_f32 v86, v86, v88
    v_add_f32 v87, v87, v89
    s_nop 0
    v_add_f32_dpp v86, v86, v86 row_ror:8 row_mask:0xf bank_mask:0xf
    v_add_f32_dpp v87, v87, v87 row_ror:8 row_mask:0xf bank_mask:0xf
    s_nop 0
    v_add_f32_dpp v86, v86, v86 row_ror:4 row_mask:0xf bank_mask:0xf
    v_add_f32_dpp v87, v87, v87 row_ror:4 row_mask:0xf bank_mask:0xf
    s_lshl_b32 s24, s28, 8
    v_bfe_u32 v5, v0, 4, 2
    v_lshlrev_b32 v5, 3, v5
    v_lshl_add_u32 v5, v2, 5, v5
    v_add_u32 v5, s24, v5
    ds_write_b64 v5, v[86:87] offset:1536
    s_waitcnt lgkmcnt(0)
    s_barrier
    s_cmp_lg_u32 s28, 0
    s_cbranch_scc1 L_mlp
    v_lshlrev_b32 v5, 3, v0
    ds_read_b64 v[8:9], v5 offset:1536
    ds_read_b64 v[10:11], v5 offset:1792
    ds_read_b64 v[12:13], v5 offset:2048
    ds_read_b64 v[14:15], v5 offset:2304
    ds_read_b64 v[16:17], v5 offset:2560
    ds_read_b64 v[18:19], v5 offset:2816
    ds_read_b64 v[20:21], v5 offset:3072
    ds_read_b64 v[22:23], v5 offset:3328
    s_mul_i32 s24, s57, 32
    v_lshl_add_u32 v6, v0, 1, s24
    v_subrev_u32 v7, 448, v6
    v_subrev_u32 v6, 1792, v6
    v_min_u32 v6, v6, v7
    v_cmp_gt_u32 vcc, 448, v6
    s_nop 1
    v_cndmask_b32 v6, 0, 1.0, vcc
    s_mul_i32 s26, s57, 128
    s_add_u32 s26, s26, 2097152
    s_mul_i32 s27, s57, 128
    s_add_u32 s27, s27, 2834432
    s_waitcnt lgkmcnt(0)
    v_add_f32 v8, v8, v16
    v_add_f32 v9, v9, v17
    v_add_f32 v10, v10, v18
    v_add_f32 v11, v11, v19
    v_add_f32 v12, v12, v20
    v_add_f32 v13, v13, v21
    v_add_f32 v14, v14, v22
    v_add_f32 v15, v15, v23
    v_add_f32 v8, v8, v12
    v_add_f32 v9, v9, v13
    v_add_f32 v10, v10, v14
    v_add_f32 v11, v11, v15
    v_add_f32 v8, v8, v10
    v_add_f32 v9, v9, v11
    v_cvt_pk_bf16_f32 v8, v8, v9
    v_and_b32 v9, 0xffff0000, v8
    v_lshlrev_b32 v8, 16, v8
    v_add_f32 v8, v6, v8
    v_add_f32 v9, v6, v9
    v_cvt_pk_bf16_f32 v8, v8, v9
    v_and_b32 v9, 0xffff0000, v8
    v_lshlrev_b32 v8, 16, v8
    s_mov_b32 exec_lo, 0xffff
    s_mov_b32 exec_hi, 0x0
    buffer_store_dwordx2 v[8:9], v5, s[12:15], s26 offen sc1
    v_mov_b32 v10, s63
    v_lshlrev_b32 v11, 15, v0
    s_waitcnt vmcnt(0)
    s_mov_b64 exec, 1
    buffer_store_dword v10, v11, s[12:15], s27 offen sc1
    s_mov_b64 exec, -1
L_mlp:
    s_barrier
L_mlp2:
    s_waitcnt lgkmcnt(0)
    v_and_b32 v1, 63, v0
    v_and_b32 v2, 15, v0
    v_bfe_u32 v3, v0, 4, 2
    v_lshlrev_b32 v4, 4, v1
    s_cmp_lt_u32 s39, 3
    s_cbranch_scc1 L_go
    s_add_u32 s36, s57, 1
    s_mul_i32 s36, s36, 128
    s_add_u32 s36, s36, 2834432
    v_mov_b32 v5, 0
    s_mov_b32 s37, 131072
    s_mov_b64 exec, 1
L_pg:
    buffer_load_dword v6, v5, s[12:15], s36 offen sc1
    s_sub_u32 s37, s37, 1
    s_cbranch_scc1 L_go
    s_waitcnt vmcnt(0)
    v_cmp_ne_u32 vcc, s63, v6
    s_cbranch_vccnz L_pg
L_go:
    s_mov_b64 exec, -1
    v_mul_u32_u24 v103, 3584, v1
    s_cmp_lt_u32 s32, 2
    s_cbranch_scc1 L_nopf
    s_and_b32 s36, s29, 3
    s_mul_i32 s36, s36, 112
    s_and_b32 s37, s28, 1
    s_mul_i32 s37, s37, 56
    s_add_u32 s36, s36, s37
    s_mul_i32 s36, s36, 3584
    s_lshr_b32 s37, s29, 2
    s_lshl_b32 s37, s37, 7
    s_add_u32 s36, s36, s37
    s_mov_b32 exec_lo, 0xffffffff
    s_mov_b32 exec_hi, 0xffffff
    buffer_load_dword v104, v103, s[52:55], s36 offen
    s_mov_b64 exec, -1
    s_branch L_pfend
L_nopf:
    s_cmp_eq_u32 s28, 0
    s_cbranch_scc1 L_pfend
    s_sub_u32 s36, s28, 3
    s_max_i32 s36, s36, 0
    s_lshl_b32 s37, s36, 10
    s_mul_i32 s38, s29, 14336
    s_add_u32 s38, s38, s37
    s_add_u32 s37, s37, 33792
    s_mov_b32 m0, s37
    s_add_u32 s37, s37, 3072
    buffer_load_dwordx4 v4, s[20:23], s38 offen lds
    s_add_u32 s38, s38, 3072
    s_mov_b32 m0, s37
    s_add_u32 s37, s37, 3072
    buffer_load_dwordx4 v4, s[20:23], s38 offen lds
    s_add_u32 s38, s38, 3072
    s_mov_b32 m0, s37
    s_add_u32 s37, s37, 3072
    buffer_load_dwordx4 v4, s[20:23], s38 offen lds
    s_add_u32 s38, s38, 3072
    s_mov_b32 m0, s37
    s_add_u32 s37, s37, 3072
    buffer_load_dwordx4 v4, s[20:23], s38 offen lds
    s_add_u32 s38, s38, 3072
    s_mov_b32 m0, s37
    s_add_u32 s37, s37, 3072
    buffer_load_dwordx4 v4, s[20:23], s38 offen lds
    s_add_u32 s38, s38, 3072
L_pfend:
    v_bfe_u32 v12, v0, 2, 2
    v_lshl_add_u32 v13, v3, 2, v12
    v_lshl_add_u32 v12, v3, 3, v12
    v_lshlrev_b32 v13, 5, v13
    v_bfe_u32 v14, v0, 1, 1
    v_mul_u32_u24 v14, 14352, v14
    v_and_b32 v15, 1, v0
    v_lshl_add_u32 v14, v15, 3, v14
    s_and_b32 s36, s28, 1
    s_lshl_b32 s36, s36, 4
    s_add_u32 s36, s36, 4096
    v_add3_u32 v13, v13, v14, s36
    v_and_b32 v12, 15, v12
    v_mul_u32_u24 v12, 896, v12
    v_and_b32 v14, 3, v0
    v_lshl_add_u32 v12, v14, 3, v12
    s_mul_i32 s36, s32, 224
    s_add_u32 s36, s36, 33792
    v_add_u32 v12, s36, v12
    v_mov_b32 v8, 0
    v_mov_b32 v9, 0
    v_mov_b32 v10, 0
    v_mov_b32 v11, 0
    ds_write_b128 v8, v[8:11] offset:64
    s_mov_b32 s24, s30
    s_and_b32 s25, s31, 0xffff
    s_mov_b32 s26, 1835008
    s_mov_b32 s27, 0x00020000
    s_waitcnt vmcnt(0) lgkmcnt(0)
    s_barrier
    s_mov_b32 m0, s34
    s_add_u32 s34, s34, 4096
    buffer_load_dwordx4 v101, s[52:55], s33 offen lds
    s_add_u32 s33, s33, 458752
    s_mov_b32 m0, s34
    s_add_u32 s34, s34, 4096
    buffer_load_dwordx4 v101, s[52:55], s33 offen lds
    s_add_u32 s33, s33, 458752
    s_mov_b32 m0, s34
    s_add_u32 s34, s34, 4096
    buffer_load_dwordx4 v101, s[52:55], s33 offen lds
    s_add_u32 s33, s33, 458752
    s_cmp_ge_u32 s32, 2
    s_cbranch_scc1 L_mg
    s_mov_b32 m0, s34
    s_add_u32 s34, s34, 4096
    buffer_load_dwordx4 v101, s[52:55], s33 offen lds
    s_add_u32 s33, s33, 458752
L_mg:
    ds_read_b64_tr_b16 v[72:73], v12 offset:0
    ds_read_b64_tr_b16 v[74:75], v12 offset:3584
    ds_read_b64_tr_b16 v[76:77], v12 offset:32
    ds_read_b64_tr_b16 v[78:79], v12 offset:3616
    ds_read_b64_tr_b16 v[80:81], v12 offset:64
    ds_read_b64_tr_b16 v[82:83], v12 offset:3648
    ds_read_b64_tr_b16 v[84:85], v12 offset:96
    ds_read_b64_tr_b16 v[86:87], v12 offset:3680
    ds_read_b64_tr_b16 v[88:89], v12 offset:128
    ds_read_b64_tr_b16 v[90:91], v12 offset:3712
    ds_read_b64_tr_b16 v[92:93], v12 offset:160
    ds_read_b64_tr_b16 v[94:95], v12 offset:3744
    ds_read_b64_tr_b16 v[96:97], v12 offset:192
    ds_read_b64_tr_b16 v[98:99], v12 offset:3776
    s_mov_b32 s40, 0
    v_mul_u32_u24 v244, 128, v1
    v_add_u32 v244, s40, v244
    s_mul_i32 s40, s28, 2048
    s_add_u32 s40, s40, 2818048
    s_mov_b32 s39, 131072
    s_mov_b64 vcc, 0xffff
L_pfm:
    s_mov_b64 exec, vcc
L_pflm:
    buffer_load_dword v255, v244, s[12:15], s40 offen sc1
    s_sub_u32 s39, s39, 1
    s_cbranch_scc1 L_pfdm
L_pfcm:
    s_waitcnt vmcnt(0)
    v_cmp_ne_u32 vcc, s63, v255
    s_nop 0
    s_mov_b64 exec, vcc
    s_cbranch_vccz L_pfdm
    s_branch L_pflm
L_pfdm:
    s_mov_b64 exec, -1
    s_waitcnt vmcnt(0) lgkmcnt(0)
    s_barrier
    s_cmp_gt_u32 s28, 4
    s_cbranch_scc1 L_fin
    s_cmp_eq_u32 s28, 4
    s_cbranch_scc1 L_poller
    s_cmp_ge_u32 s28, 2
    s_cbranch_scc1 L_nogw
    ds_read_b64_tr_b16 v[16:17], v13 offset:0
    ds_read_b64_tr_b16 v[18:19], v13 offset:512
    ds_read_b64_tr_b16 v[20:21], v13 offset:1024
    ds_read_b64_tr_b16 v[22:23], v13 offset:1536
    ds_read_b64_tr_b16 v[24:25], v13 offset:2048
    ds_read_b64_tr_b16 v[26:27], v13 offset:2560
    ds_read_b64_tr_b16 v[28:29], v13 offset:3072
    ds_read_b64_tr_b16 v[30:31], v13 offset:3584
    ds_read_b64_tr_b16 v[32:33], v13 offset:4096
    ds_read_b64_tr_b16 v[34:35], v13 offset:4608
    ds_read_b64_tr_b16 v[36:37], v13 offset:5120
    ds_read_b64_tr_b16 v[38:39], v13 offset:5632
    ds_read_b64_tr_b16 v[40:41], v13 offset:6144
    ds_read_b64_tr_b16 v[42:43], v13 offset:6656
    s_waitcnt lgkmcnt(0)
    ds_read_b64_tr_b16 v[44:45], v13 offset:7168
    ds_read_b64_tr_b16 v[46:47], v13 offset:7680
    ds_read_b64_tr_b16 v[48:49], v13 offset:8192
    ds_read_b64_tr_b16 v[50:51], v13 offset:8704
    ds_read_b64_tr_b16 v[52:53], v13 offset:9216
    ds_read_b64_tr_b16 v[54:55], v13 offset:9728
    ds_read_b64_tr_b16 v[56:57], v13 offset:10240
    ds_read_b64_tr_b16 v[58:59], v13 offset:10752
    ds_read_b64_tr_b16 v[60:61], v13 offset:11264
    ds_read_b64_tr_b16 v[62:63], v13 offset:11776
    ds_read_b64_tr_b16 v[64:65], v13 offset:12288
    ds_read_b64_tr_b16 v[66:67], v13 offset:12800
    ds_read_b64_tr_b16 v[68:69], v13 offset:13312
    ds_read_b64_tr_b16 v[70:71], v13 offset:13824
    s_branch L_nogw
L_nogw:
    v_lshlrev_b32 v101, 4, v3
    v_and_b32 v102, 1, v3
    v_lshlrev_b32 v102, 3, v102
    v_lshrrev_b32 v103, 1, v3
    v_lshl_add_u32 v102, v103, 2, v102
    s_lshl_b32 s36, s28, 4
    v_add_u32 v102, s36, v102
    v_lshlrev_b32 v103, 4, v3
    v_lshl_add_u32 v105, v3, 3, v2
    v_and_b32 v105, 0x1f, v105
    v_lshrrev_b32 v104, 1, v3
    v_lshl_add_u32 v105, v104, 4, v2
    v_cmp_eq_u32 vcc, 0, v105
    s_nop 1
    v_cndmask_b32 v172, 64, v103, vcc
    v_cmp_eq_u32 vcc, 1, v105
    s_nop 1
    v_cndmask_b32 v173, 64, v103, vcc
    v_cmp_eq_u32 vcc, 2, v105
    s_nop 1
    v_cndmask_b32 v174, 64, v103, vcc
    v_cmp_eq_u32 vcc, 3, v105
    s_nop 1
    v_cndmask_b32 v175, 64, v103, vcc
    v_cmp_eq_u32 vcc, 4, v105
    s_nop 1
    v_cndmask_b32 v176, 64, v103, vcc
    v_cmp_eq_u32 vcc, 5, v105
    s_nop 1
    v_cndmask_b32 v177, 64, v103, vcc
    v_cmp_eq_u32 vcc, 6, v105
    s_nop 1
    v_cndmask_b32 v178, 64, v103, vcc
    v_lshlrev_b32 v104, 6, v2
    v_lshl_add_u32 v104, v3, 4, v104
    s_lshl_b32 s37, s29, 11
    s_lshl_b32 s36, s28, 9
    s_add_u32 s37, s37, s36
    s_add_u32 s37, s37, 2393856
    v_cmp_gt_u32 s[50:51], 7, v2
    v_lshlrev_b32 v106, 2, v3
    v_lshlrev_b32 v7, 3, v3
    s_lshr_b32 s56, s29, 1
    s_lshl_b32 s35, s56, 5
    s_add_u32 s35, s35, 2106112
    v_mov_b32 v115, 0
    s_waitcnt lgkmcnt(0)
    s_barrier
    ds_read_b64 v[112:113], v115 offset:1024
    s_cmp_ge_u32 s28, 2
    s_cbranch_scc1 L_nogu
    ds_read_b128 v[116:119], v101 offset:128
    ds_read_b128 v[120:123], v101 offset:192
    ds_read_b128 v[124:127], v101 offset:256
    ds_read_b128 v[128:131], v101 offset:320
    ds_read_b128 v[132:135], v101 offset:384
    ds_read_b128 v[136:139], v101 offset:448
    ds_read_b128 v[140:143], v101 offset:512
    ds_read_b128 v[144:147], v101 offset:576
    ds_read_b128 v[148:151], v101 offset:640
    ds_read_b128 v[152:155], v101 offset:704
    ds_read_b128 v[156:159], v101 offset:768
    ds_read_b128 v[160:163], v101 offset:832
    ds_read_b128 v[164:167], v101 offset:896
    ds_read_b128 v[168:171], v101 offset:960
    s_waitcnt lgkmcnt(13)
    v_mfma_f32_16x16x32_bf16 v[108:111], v[16:19], v[116:119], 0
    s_waitcnt lgkmcnt(12)
    v_mfma_f32_16x16x32_bf16 v[108:111], v[20:23], v[120:123], v[108:111]
    s_waitcnt lgkmcnt(11)
    v_mfma_f32_16x16x32_bf16 v[108:111], v[24:27], v[124:127], v[108:111]
    s_waitcnt lgkmcnt(10)
    v_mfma_f32_16x16x32_bf16 v[108:111], v[28:31], v[128:131], v[108:111]
    s_waitcnt lgkmcnt(9)
    v_mfma_f32_16x16x32_bf16 v[108:111], v[32:35], v[132:135], v[108:111]
    s_waitcnt lgkmcnt(8)
    v_mfma_f32_16x16x32_bf16 v[108:111], v[36:39], v[136:139], v[108:111]
    s_waitcnt lgkmcnt(7)
    v_mfma_f32_16x16x32_bf16 v[108:111], v[40:43], v[140:143], v[108:111]
    s_waitcnt lgkmcnt(6)
    v_mfma_f32_16x16x32_bf16 v[108:111], v[44:47], v[144:147], v[108:111]
    s_waitcnt lgkmcnt(5)
    v_mfma_f32_16x16x32_bf16 v[108:111], v[48:51], v[148:151], v[108:111]
    s_waitcnt lgkmcnt(4)
    v_mfma_f32_16x16x32_bf16 v[108:111], v[52:55], v[152:155], v[108:111]
    s_waitcnt lgkmcnt(3)
    v_mfma_f32_16x16x32_bf16 v[108:111], v[56:59], v[156:159], v[108:111]
    s_waitcnt lgkmcnt(2)
    v_mfma_f32_16x16x32_bf16 v[108:111], v[60:63], v[160:163], v[108:111]
    s_waitcnt lgkmcnt(1)
    v_mfma_f32_16x16x32_bf16 v[108:111], v[64:67], v[164:167], v[108:111]
    s_waitcnt lgkmcnt(0)
    v_mfma_f32_16x16x32_bf16 v[108:111], v[68:71], v[168:171], v[108:111]
    s_nop 7
    v_permlane32_swap_b32 v108, v110
    v_permlane32_swap_b32 v109, v111
    v_cvt_pk_bf16_f32 v108, v108, v109
    v_cvt_pk_bf16_f32 v110, v110, v111
    v_and_b32 v109, 0xffff0000, v108
    v_lshlrev_b32 v108, 16, v108
    v_mul_f32 v181, 0xbfb8aa3b, v109
    v_mul_f32 v180, 0xbfb8aa3b, v108
    v_exp_f32 v181, v181
    v_exp_f32 v180, v180
    v_and_b32 v111, 0xffff0000, v110
    v_add_f32 v181, 1.0, v181
    v_add_f32 v180, 1.0, v180
    v_rcp_f32 v181, v181
    v_rcp_f32 v180, v180
    v_lshlrev_b32 v110, 16, v110
    v_mul_f32 v109, v109, v181
    v_mul_f32 v108, v108, v180
    v_cvt_pk_bf16_f32 v108, v108, v109
    v_and_b32 v109, 0xffff0000, v108
    v_lshlrev_b32 v108, 16, v108
    v_mul_f32 v108, v108, v110
    v_mul_f32 v109, v109, v111
    v_cvt_pk_bf16_f32 v108, v108, v109
    ds_write_b32 v102, v108 offset:0
L_nogu:
    s_waitcnt lgkmcnt(0)
    s_barrier
    ds_read_b128 v[116:119], v172 offset:0
    ds_read_b128 v[120:123], v173 offset:0
    ds_read_b128 v[124:127], v174 offset:0
    ds_read_b128 v[128:131], v175 offset:0
    ds_read_b128 v[132:135], v176 offset:0
    ds_read_b128 v[136:139], v177 offset:0
    ds_read_b128 v[140:143], v178 offset:0
    v_readfirstlane_b32 s42, v112
    v_readfirstlane_b32 s43, v113
    s_waitcnt lgkmcnt(6)
    v_mfma_f32_16x16x32_bf16 v[108:111], v[72:75], v[116:119], 0
    s_waitcnt lgkmcnt(5)
    v_mfma_f32_16x16x32_bf16 v[108:111], v[76:79], v[120:123], v[108:111]
    s_waitcnt lgkmcnt(4)
    v_mfma_f32_16x16x32_bf16 v[108:111], v[80:83], v[124:127], v[108:111]
    s_waitcnt lgkmcnt(3)
    v_mfma_f32_16x16x32_bf16 v[108:111], v[84:87], v[128:131], v[108:111]
    s_waitcnt lgkmcnt(2)
    v_mfma_f32_16x16x32_bf16 v[108:111], v[88:91], v[132:135], v[108:111]
    s_waitcnt lgkmcnt(1)
    v_mfma_f32_16x16x32_bf16 v[108:111], v[92:95], v[136:139], v[108:111]
    s_waitcnt lgkmcnt(0)
    v_mfma_f32_16x16x32_bf16 v[108:111], v[96:99], v[140:143], v[108:111]
    s_and_b32 s45, s42, 0x7ff
    s_lshl_b32 s46, s56, 4
    s_add_u32 s46, s46, s43
    s_mov_b32 s39, 131072
    s_mov_b64 exec, s[50:51]
    s_nop 2
    buffer_store_dwordx4 v[108:111], v104, s[12:15], s37 offen sc1
    s_mov_b32 exec_lo, 0xffffffff
    s_mov_b32 exec_hi, 0xffffff
    s_cmp_lg_u32 s28, 0
    s_cbranch_scc1 L_copyout
    s_bitcmp1_b32 s29, 0
    s_cbranch_scc1 L_fin
    s_mul_i32 s36, s56, 4682
    s_lshr_b32 s36, s36, 16
    s_mul_i32 s37, s36, 64
    s_lshl_b32 s36, s56, 5
    s_add_u32 s37, s37, s36
    s_add_u32 s37, s37, 2393856
    s_add_u32 s38, s37, 114688
    v_lshlrev_b32 v105, 11, v1
    buffer_load_dwordx2 v[8:9], v7, s[12:15], s35 offen sc1
    s_and_b32 s47, s42, 0xfffff800
    s_ashr_i32 s48, s47, 31
    s_not_b32 s48, s48
    s_or_b32 s48, s48, 0x80000000
    s_xor_b32 s47, s47, s48
    v_mov_b32 v114, s47
    s_mov_b64 exec, -1
    v_mov_b32 v116, 0
    v_mov_b32 v117, 0
    v_mov_b32 v118, 0
    v_mov_b32 v119, 0
    v_mov_b32 v120, 0
    v_mov_b32 v121, 0
    v_mov_b32 v122, 0
    v_mov_b32 v123, 0
    v_mov_b32 v124, 0
    v_mov_b32 v125, 0
    v_mov_b32 v126, 0
    v_mov_b32 v127, 0
    v_mov_b32 v128, 0
    v_mov_b32 v129, 0
    v_mov_b32 v130, 0
    v_mov_b32 v131, 0
    s_mov_b32 exec_lo, 0xffffffff
    s_mov_b32 exec_hi, 0xffffff
    s_waitcnt vmcnt(0)
L_pollp:
    buffer_load_dwordx4 v[116:119], v105, s[12:15], s37 offen sc1
    buffer_load_dwordx4 v[120:123], v105, s[12:15], s37 offen offset:16 sc1
    buffer_load_dwordx4 v[124:127], v105, s[12:15], s38 offen sc1
    buffer_load_dwordx4 v[128:131], v105, s[12:15], s38 offen offset:16 sc1
    buffer_load_dword v107, v106, s[12:15], s46 offen offset:896 sc1
    v_cvt_pk_bf16_f32 v132, v114, v114
    v_lshlrev_b32 v132, 16, v132
    v_mul_f32 v132, 0xbfb8aa3b, v132
    v_exp_f32 v132, v132
    s_sub_u32 s39, s39, 1
    v_add_f32 v132, 1.0, v132
    v_rcp_f32 v132, v132
    s_cbranch_scc1 L_pdone
    v_cvt_pk_bf16_f32 v132, v132, v132
    v_lshlrev_b32 v132, 16, v132
    s_waitcnt vmcnt(3)
    v_max3_u32 v112, v116, v117, v118
    v_max3_u32 v113, v119, v120, v121
    v_max3_u32 v112, v112, v122, v123
    s_waitcnt vmcnt(0)
    v_max3_u32 v113, v113, v124, v125
    v_max3_u32 v112, v112, v126, v127
    v_max3_u32 v113, v113, v128, v129
    v_max3_u32 v112, v112, v130, v131
    v_max3_u32 v112, v112, v113, v107
    v_cmp_eq_u32 vcc, -1, v112
    s_nop 0
    s_mov_b64 exec, vcc
    s_cbranch_vccnz L_pollp
L_pdone:
    s_waitcnt vmcnt(0)
    s_mov_b64 exec, -1
    v_add_f32 v116, v116, v124
    v_add_f32 v117, v117, v125
    v_add_f32 v118, v118, v126
    v_add_f32 v119, v119, v127
    v_add_f32 v120, v120, v128
    v_add_f32 v121, v121, v129
    v_add_f32 v122, v122, v130
    v_add_f32 v123, v123, v131
    v_permlane32_swap_b32 v116, v120
    v_permlane32_swap_b32 v117, v121
    v_permlane32_swap_b32 v118, v122
    v_permlane32_swap_b32 v119, v123
    v_add_f32 v116, v116, v120
    v_add_f32 v117, v117, v121
    v_add_f32 v118, v118, v122
    v_add_f32 v119, v119, v123
    s_nop 0
    v_permlane16_swap_b32 v116, v118
    v_permlane16_swap_b32 v117, v119
    v_add_f32 v116, v116, v118
    v_add_f32 v117, v117, v119
    s_nop 0
    v_add_f32_dpp v116, v116, v116 row_ror:8 row_mask:0xf bank_mask:0xf
    v_add_f32_dpp v117, v117, v117 row_ror:8 row_mask:0xf bank_mask:0xf
    s_nop 0
    v_add_f32_dpp v116, v116, v116 row_ror:4 row_mask:0xf bank_mask:0xf
    v_add_f32_dpp v117, v117, v117 row_ror:4 row_mask:0xf bank_mask:0xf
    s_nop 0
    v_add_f32_dpp v116, v116, v116 row_ror:2 row_mask:0xf bank_mask:0xf
    v_add_f32_dpp v117, v117, v117 row_ror:2 row_mask:0xf bank_mask:0xf
    s_nop 0
    v_add_f32_dpp v116, v116, v116 row_ror:1 row_mask:0xf bank_mask:0xf
    v_add_f32_dpp v117, v117, v117 row_ror:1 row_mask:0xf bank_mask:0xf
    v_lshlrev_b32 v118, 16, v107
    v_cvt_pk_bf16_f32 v116, v116, v117
    v_and_b32 v119, 0xffff0000, v107
    v_and_b32 v117, 0xffff0000, v116
    v_lshlrev_b32 v116, 16, v116
    v_mul_f32 v116, v116, v132
    v_mul_f32 v117, v117, v132
    v_cvt_pk_bf16_f32 v116, v116, v117
    v_and_b32 v117, 0xffff0000, v116
    v_lshlrev_b32 v116, 16, v116
    v_fmac_f32 v118, v116, v8
    v_fmac_f32 v119, v117, v9
    v_cvt_pk_bf16_f32 v118, v118, v119
    s_mul_i32 s37, s45, 896
    s_lshl_b32 s36, s56, 4
    s_add_u32 s37, s37, s36
    s_mov_b32 exec_lo, 0x10001
    s_mov_b32 exec_hi, 0x10001
    buffer_store_dword v118, v106, s[24:27], s37 offen
    s_cmp_lg_u32 s29, 0
    s_cbranch_scc1 L_fin
    v_mov_b32 v116, s63
    v_mov_b32 v117, 2109440
    s_mov_b64 exec, 1
    buffer_store_dword v116, v117, s[12:15], 0 offen sc1
    s_branch L_fin
L_poller:
    s_mul_i32 s38, s3, 18432
    s_add_u32 s38, s38, 2654208
    s_add_u32 s40, s38, 8192
    s_add_u32 s41, s38, 16384
    s_mov_b32 s39, 131072
    v_lshlrev_b32 v115, 7, v1
    v_mov_b32 v128, 0
    v_mov_b32 v129, s63
    s_mov_b64 s[46:47], -1
    s_mov_b64 s[48:49], -1
    s_mov_b64 s[50:51], 1
    v_and_b32 v119, 0xfc, v1
    v_lshlrev_b32 v119, 4, v119
    v_and_b32 v120, 1, v1
    v_lshl_add_u32 v119, v120, 5, v119
    v_bfe_u32 v120, v1, 1, 1
    v_lshl_add_u32 v119, v120, 3, v119
    s_mov_b32 s42, 0
    s_mov_b32 s43, 2162688
    v_cmp_gt_u32 vcc, 56, v1
    v_mov_b32 v125, 0
    v_mov_b32 v126, 0
    v_cndmask_b32 v124, 0, -1, vcc
    v_mov_b32 v127, 0
    v_mov_b32 v118, 0
    s_mov_b64 exec, s[46:47]
    buffer_load_dwordx2 v[108:109], v115, s[12:15], s38 offen sc1
    s_mov_b64 exec, s[48:49]
    buffer_load_dwordx2 v[110:111], v115, s[12:15], s40 offen sc1
    s_mov_b64 exec, s[50:51]
    buffer_load_dwordx2 v[128:129], v115, s[12:15], s41 offen sc1
    s_mov_b64 exec, -1
L_pollkey:
    s_sub_u32 s39, s39, 1
    s_cbranch_scc1 L_keydone
    s_waitcnt vmcnt(0)
    v_cmp_ne_u32 s[46:47], s63, v109
    v_cmp_ne_u32 s[48:49], s63, v111
    v_cmp_ne_u32 s[50:51], s63, v129
    s_or_b64 vcc, s[46:47], s[48:49]
    s_or_b64 vcc, vcc, s[50:51]
    s_cbranch_scc0 L_keydone
    v_cndmask_b32 v130, v108, 0, s[46:47]
    v_cndmask_b32 v112, v110, 0, s[48:49]
    v_cndmask_b32 v113, v128, 0, s[50:51]
    s_mov_b64 exec, s[46:47]
    buffer_load_dwordx2 v[108:109], v115, s[12:15], s38 offen sc1
    s_mov_b64 exec, s[48:49]
    buffer_load_dwordx2 v[110:111], v115, s[12:15], s40 offen sc1
    s_mov_b64 exec, s[50:51]
    buffer_load_dwordx2 v[128:129], v115, s[12:15], s41 offen sc1
    s_mov_b64 exec, -1
    v_max3_u32 v113, v130, v112, v113
    s_nop 1
    v_max_u32_dpp v113, v113, v113 row_ror:8 row_mask:0xf bank_mask:0xf
    s_nop 1
    v_max_u32_dpp v113, v113, v113 row_ror:4 row_mask:0xf bank_mask:0xf
    s_nop 1
    v_max_u32_dpp v113, v113, v113 row_ror:2 row_mask:0xf bank_mask:0xf
    s_nop 1
    v_max_u32_dpp v113, v113, v113 row_ror:1 row_mask:0xf bank_mask:0xf
    s_nop 0
    v_readlane_b32 s56, v113, 0
    v_readlane_b32 s57, v113, 16
    v_readlane_b32 s44, v113, 32
    v_readlane_b32 s45, v113, 48
    s_max_u32 s56, s56, s57
    s_max_u32 s44, s44, s45
    s_max_u32 s56, s56, s44
    s_cmp_eq_u32 s56, s42
    s_cbranch_scc0 L_spec
    v_max3_u32 v120, v124, v125, v126
    v_max_u32 v120, v120, v127
    v_cmp_eq_u32 vcc, -1, v120
    s_cbranch_vccz L_pollkey
    s_cmp_eq_u32 s56, 0
    s_cbranch_scc1 L_pollkey
    s_branch L_spec2
L_spec:
    s_mov_b32 s42, s56
    v_cmp_eq_u32 s[58:59], s42, v130
    v_cmp_eq_u32 s[60:61], s42, v112
    s_ff1_i32_b64 s43, s[58:59]
    s_ff1_i32_b64 s44, s[60:61]
    s_add_u32 s44, s44, 64
    s_cmp_lg_u64 s[60:61], 0
    s_cselect_b32 s44, s44, 128
    s_cmp_lg_u64 s[58:59], 0
    s_cselect_b32 s43, s43, s44
    s_mul_i32 s43, s43, 1792
    s_add_u32 s43, s43, 2162688
L_spec2:
    s_mov_b32 exec_lo, 0xffffffff
    s_mov_b32 exec_hi, 0xffffff
    buffer_load_dwordx4 v[124:127], v4, s[12:15], s43 offen sc1
    s_mov_b64 exec, -1
    s_branch L_pollkey
L_keydone:
    s_waitcnt vmcnt(0)
    v_max3_u32 v113, v108, v110, v128
    v_max3_u32 v120, v124, v125, v126
    v_max_u32 v120, v120, v127
    v_max_u32_dpp v113, v113, v113 row_ror:8 row_mask:0xf bank_mask:0xf
    s_nop 1
    v_max_u32_dpp v113, v113, v113 row_ror:4 row_mask:0xf bank_mask:0xf
    s_nop 1
    v_max_u32_dpp v113, v113, v113 row_ror:2 row_mask:0xf bank_mask:0xf
    s_nop 1
    v_max_u32_dpp v113, v113, v113 row_ror:1 row_mask:0xf bank_mask:0xf
    s_nop 0
    v_readlane_b32 s56, v113, 0
    v_readlane_b32 s57, v113, 16
    v_readlane_b32 s44, v113, 32
    v_readlane_b32 s45, v113, 48
    s_max_u32 s56, s56, s57
    s_max_u32 s44, s44, s45
    s_max_u32 s56, s56, s44
    s_mov_b32 s39, 131072
    v_mov_b32 v116, s56
    s_cmp_eq_u32 s56, s42
    s_cbranch_scc1 L_same
    v_cmp_eq_u32 s[58:59], s56, v108
    v_cmp_eq_u32 s[60:61], s56, v110
    s_ff1_i32_b64 s43, s[58:59]
    s_ff1_i32_b64 s44, s[60:61]
    s_add_u32 s44, s44, 64
    s_cmp_lg_u64 s[60:61], 0
    s_cselect_b32 s44, s44, 128
    s_cmp_lg_u64 s[58:59], 0
    s_cselect_b32 s43, s43, s44
    s_mul_i32 s43, s43, 1792
    s_add_u32 s43, s43, 2162688
    s_mov_b32 exec_lo, 0xffffffff
    s_mov_b32 exec_hi, 0xffffff
L_pollh:
    buffer_load_dwordx4 v[124:127], v4, s[12:15], s43 offen sc1
    s_sub_u32 s39, s39, 1
    s_cbranch_scc1 L_hdone
    s_waitcnt vmcnt(0)
    v_max3_u32 v120, v124, v125, v126
    v_max_u32 v120, v120, v127
L_same:
    s_mov_b32 exec_lo, 0xffffffff
    s_mov_b32 exec_hi, 0xffffff
    v_cmp_eq_u32 vcc, -1, v120
    s_cbranch_vccnz L_pollh
L_hdone:
    s_waitcnt vmcnt(0)
    v_mov_b32 v117, s43
    ds_write2_b64 v119, v[124:125], v[126:127] offset0:16 offset1:18
    ds_write_b64 v118, v[116:117] offset:1024
    s_waitcnt lgkmcnt(0)
    s_barrier
    s_branch L_fin
L_copyout:
    s_sub_u32 s36, s28, 1
    s_mul_i32 s36, s36, 112
    s_add_u32 s36, s36, s29
    s_cmp_ge_u32 s36, 129
    s_cbranch_scc1 L_fin
    s_lshl_b32 s37, s36, 7
    s_mul_i32 s38, s3, 18432
    s_add_u32 s37, s37, s38
    s_add_u32 s37, s37, 2654208
    s_mul_i32 s36, s36, 1792
    s_add_u32 s36, s36, 2162688
    v_mov_b32 v105, 0
L_pollc:
    buffer_load_dword v112, v105, s[12:15], s37 offen sc1
    buffer_load_dwordx4 v[116:119], v4, s[12:15], s36 offen offset:896 sc1
    s_sub_u32 s39, s39, 1
    s_cbranch_scc1 L_cdone
    s_waitcnt vmcnt(0)
    v_max3_u32 v113, v116, v117, v118
    v_max_u32 v113, v113, v119
    v_cmp_eq_u32 vcc, -1, v113
    s_cbranch_vccnz L_pollc
L_cdone:
    s_waitcnt vmcnt(0)
    v_readfirstlane_b32 s36, v112
    s_nop 0
    s_and_b32 s36, s36, 0x7ff
    s_cmp_eq_u32 s36, s45
    s_cbranch_scc1 L_fin
    s_mul_i32 s36, s36, 896
    buffer_store_dwordx4 v[116:119], v4, s[24:27], s36 offen
L_fin:
    s_endpgm
L_end:
    s_endpgm
.section .rodata,"a"
.p2align 6
.amdhsa_kernel adaLN_cond__spectral_fnet__moe_arch_mod__prompt_kernel
  .amdhsa_next_free_vgpr 256
  .amdhsa_next_free_sgpr 96
  .amdhsa_accum_offset 256
  .amdhsa_group_segment_fixed_size 0
  .amdhsa_kernarg_size 120
  .amdhsa_user_sgpr_count 2
  .amdhsa_user_sgpr_kernarg_segment_ptr 1
  .amdhsa_system_sgpr_workgroup_id_x 1
  .amdhsa_float_denorm_mode_32 3
  .amdhsa_float_denorm_mode_16_64 3
.end_amdhsa_kernel
```
